```python
import torch

def _softmax(x, axis=-1):
    return torch.softmax(x, dim=axis)

def _gelu(x):
    return torch.nn.functional.gelu(x, approximate='tanh')

def _silu(x):
    return torch.nn.functional.silu(x)

def _sigmoid(x):
    return torch.sigmoid(x)

def _layernorm(x, axis=-1, eps=1e-05):
    m = x.mean(dim=axis, keepdim=True)
    v = x.var(dim=axis, keepdim=True, unbiased=False)
    return (x - m) / torch.sqrt(v + eps)

def _scatter_add(tgt, idx, src, axis=0):
    return tgt.clone().index_add_(axis, idx, src)

def _segment_sum(src, seg, n):
    out = torch.zeros((n,) + src.shape[1:], dtype=src.dtype)
    return out.index_add_(0, seg, src)

def _pad(x, pw):
    flat = tuple((v for pair in reversed(pw) for v in pair))
    return torch.nn.functional.pad(x, flat)
kernel_name = 'adaLN_cond__grouped_kv_mqa__mixer_channel_mlp__prompt'

def setup_inputs():

    _w = lambda a: (lambda t: t.to(torch.bfloat16) if t.is_floating_point() else t)(torch.as_tensor(a))

    def _A_setup():
        B, S, D, H = (1, 2048, 640, 32)
        Dh = D // H
        return {'x': _w((lambda *s: torch.randn(*s, dtype=torch.bfloat16) * 0.05)(B, S, D)), 'wq': _w((lambda *s: torch.randn(*s, dtype=torch.bfloat16) * 0.05)(D, H * Dh)), 'wk': _w((lambda *s: torch.randn(*s, dtype=torch.bfloat16) * 0.05)(D, Dh)), 'wv': _w((lambda *s: torch.randn(*s, dtype=torch.bfloat16) * 0.05)(D, Dh)), 'wo': _w((lambda *s: torch.randn(*s, dtype=torch.bfloat16) * 0.05)(H * Dh, D))}
    _A_in = _A_setup()

    def _B_setup():
        B, S, D, F = (1, 2048, 640, 1728)
        return {'x': _w((lambda *s: torch.randn(*s, dtype=torch.bfloat16) * 0.05)(B, S, D)), 'w1': _w((lambda *s: torch.randn(*s, dtype=torch.bfloat16) * 3.2)(D, F) * D ** (-0.5)), 'b1': _w((lambda *s: torch.randn(*s, dtype=torch.bfloat16) * 0.8)(F)), 'w2': _w((lambda *s: torch.randn(*s, dtype=torch.bfloat16) * 3.2)(F, D) * F ** (-0.5)), 'b2': _w((lambda *s: torch.randn(*s, dtype=torch.bfloat16) * 3.2)(D))}
    _B_in = _B_setup()
    return {'A_x': _A_in['x'], 'A_wq': _A_in['wq'], 'A_wk': _A_in['wk'], 'A_wv': _A_in['wv'], 'A_wo': _A_in['wo'], 'B_x': _B_in['x'], 'B_w1': _B_in['w1'], 'B_b1': _B_in['b1'], 'B_w2': _B_in['w2'], 'B_b2': _B_in['b2'], 'c': _w((lambda *s: torch.randn(*s, dtype=torch.bfloat16) * 0.1)(1, 640) * 8.0), 'w_mod': _w((lambda *s: torch.randn(*s, dtype=torch.bfloat16) * 0.1)(640, 6 * 640) * 640 ** (-0.5) * 8.0)}

def reference(A_x, A_wq, A_wk, A_wv, A_wo, B_x, B_w1, B_b1, B_w2, B_b2, c, w_mod):

    def _A_ref(x, wq, wk, wv, wo):
        B, S, D = x.shape
        H = 32
        Dh = D // H
        q = (lambda x, *d: x.permute(*d))((x @ wq).reshape(B, S, H, Dh), 0, 2, 1, 3)
        k = x @ wk
        v = x @ wv
        scores = torch.einsum('bhqd,bkd->bhqk', q, k) * Dh ** (-0.5)
        p = _softmax(scores, axis=-1)
        o = torch.einsum('bhqk,bkd->bhqd', p, v)
        return (lambda x, *d: x.permute(*d))(o, 0, 2, 1, 3).reshape(B, S, H * Dh) @ wo

    def _B_ref(x, w1, b1, w2, b2):
        y = _layernorm(x, axis=-1)
        h = _gelu(torch.einsum('bsd,df->bsf', y, w1) + b1)
        return torch.einsum('bsf,fd->bsd', h, w2) + b2
    x = A_x
    mod = (_silu(c) @ w_mod).reshape(c.shape[0], 6, 1, -1)
    sa, ca, ga, sb, cb, gb = (mod[:, 0].clone(), mod[:, 1].clone(), mod[:, 2].clone(), mod[:, 3].clone(), mod[:, 4].clone(), mod[:, 5].clone())
    h = _layernorm(x, axis=-1) * (1 + ca) + sa
    x = x + ga * _A_ref(h, A_wq, A_wk, A_wv, A_wo)
    h = _layernorm(x, axis=-1) * (1 + cb) + sb
    x = x + gb * _B_ref(h, B_w1, B_b1, B_w2, B_b2)
    return x
```

```asm
; @launch kernel=prep_kernel grid=(488,1,1) block=(256,1,1) lds=16384
; @launch kernel=main_kernel grid=(256,1,1) block=(512,1,1) lds=163840
.amdgcn_target "amdgcn-amd-amdhsa--gfx950"
.text
.globl prep_kernel
.p2align 8
.type prep_kernel,@function
prep_kernel:
    s_cmp_ge_u32 s2, 488
    s_cbranch_scc1 K0_END
    s_load_dwordx2 s[4:5], s[0:1], 112
    s_load_dwordx4 s[20:23], s[0:1], 80
    s_load_dwordx4 s[24:27], s[0:1], 0
    s_load_dwordx4 s[28:31], s[0:1], 16
    s_load_dwordx2 s[32:33], s[0:1], 32
    v_and_b32 v1, 63, v0
    v_lshrrev_b32 v2, 6, v0
    s_nop 0
    v_readfirstlane_b32 s3, v2
    s_cmp_ge_u32 s2, 32
    s_cbranch_scc1 K0_NOPF
    s_getpc_b64 s[36:37]
K0_PCREF:
    s_and_b32 s37, s37, 0xffff
    s_mov_b32 s38, CODE_END-K0_PCREF
    s_mov_b32 s39, 0x00020000
    s_lshr_b32 s34, s2, 3
    s_lshl_b32 s34, s34, 15
    v_lshlrev_b32 v94, 7, v0
    buffer_load_dword v95, v94, s[36:39], s34 offen
K0_NOPF:
    s_sub_u32 s50, s2, 248
    s_cmp_ge_u32 s2, 328
    s_cselect_b32 s50, s50, s2
    s_cselect_b32 s51, 0, s2
    s_waitcnt lgkmcnt(0)
    s_mov_b32 s12, s4
    s_and_b32 s13, s5, 0xffff
    s_mov_b32 s14, 268435456
    s_mov_b32 s15, 0x00020000
    s_cmp_ge_u32 s51, 80
    s_cbranch_scc1 K0_NOTMOD
    s_mov_b32 s8, s22
    s_and_b32 s9, s23, 0xffff
    s_mov_b32 s10, 4915200
    s_mov_b32 s11, 0x00020000
    s_mov_b32 s16, s20
    s_and_b32 s17, s21, 0xffff
    s_mov_b32 s18, 1280
    s_mov_b32 s19, 0x00020000
    s_and_b32 s40, s50, 3
    s_lshr_b32 s41, s50, 2
    s_add_u32 s41, s41, 0
    v_and_b32 v2, 7, v0
    v_lshrrev_b32 v3, 3, v0
    v_mul_u32_u24 v4, 7680, v3
    v_lshl_add_u32 v4, v2, 4, v4
    s_mul_i32 s42, s40, 1228800
    s_lshl_b32 s43, s41, 7
    s_add_u32 s42, s42, s43
    v_lshlrev_b32 v5, 1, v3
    s_mul_i32 s44, s40, 320
    buffer_load_dwordx4 v[20:23], v4, s[8:11], s42 offen
    s_add_u32 s42, s42, 245760
    buffer_load_dwordx4 v[24:27], v4, s[8:11], s42 offen
    s_add_u32 s42, s42, 245760
    buffer_load_dwordx4 v[28:31], v4, s[8:11], s42 offen
    s_add_u32 s42, s42, 245760
    buffer_load_dwordx4 v[32:35], v4, s[8:11], s42 offen
    s_add_u32 s42, s42, 245760
    buffer_load_dwordx4 v[36:39], v4, s[8:11], s42 offen
    buffer_load_ushort v10, v5, s[16:19], s44 offen offset:0
    buffer_load_ushort v11, v5, s[16:19], s44 offen offset:64
    buffer_load_ushort v12, v5, s[16:19], s44 offen offset:128
    buffer_load_ushort v13, v5, s[16:19], s44 offen offset:192
    buffer_load_ushort v14, v5, s[16:19], s44 offen offset:256
    v_mov_b32 v40, 0
    v_mov_b32 v41, 0
    v_mov_b32 v42, 0
    v_mov_b32 v43, 0
    v_mov_b32 v44, 0
    v_mov_b32 v45, 0
    v_mov_b32 v46, 0
    v_mov_b32 v47, 0
    s_waitcnt vmcnt(0)
    v_lshlrev_b32 v10, 16, v10
    v_mul_f32 v15, 0xbfb8aa3b, v10
    v_lshlrev_b32 v11, 16, v11
    v_mul_f32 v16, 0xbfb8aa3b, v11
    v_lshlrev_b32 v12, 16, v12
    v_mul_f32 v17, 0xbfb8aa3b, v12
    v_lshlrev_b32 v13, 16, v13
    v_mul_f32 v18, 0xbfb8aa3b, v13
    v_lshlrev_b32 v14, 16, v14
    v_mul_f32 v19, 0xbfb8aa3b, v14
    v_exp_f32 v15, v15
    v_exp_f32 v16, v16
    v_exp_f32 v17, v17
    v_exp_f32 v18, v18
    v_exp_f32 v19, v19
    v_add_f32 v15, 1.0, v15
    v_add_f32 v16, 1.0, v16
    v_add_f32 v17, 1.0, v17
    v_add_f32 v18, 1.0, v18
    v_add_f32 v19, 1.0, v19
    v_rcp_f32 v15, v15
    v_rcp_f32 v16, v16
    v_rcp_f32 v17, v17
    v_rcp_f32 v18, v18
    v_rcp_f32 v19, v19
    v_mul_f32 v10, v10, v15
    v_mul_f32 v11, v11, v16
    v_mul_f32 v12, v12, v17
    v_mul_f32 v13, v13, v18
    v_mul_f32 v14, v14, v19
    v_cvt_pk_bf16_f32 v10, v10, v10
    v_cvt_pk_bf16_f32 v11, v11, v11
    v_cvt_pk_bf16_f32 v12, v12, v12
    v_cvt_pk_bf16_f32 v13, v13, v13
    v_cvt_pk_bf16_f32 v14, v14, v14
    v_and_b32 v15, 0xffff0000, v10
    v_and_b32 v10, 0xffff, v10
    v_and_b32 v16, 0xffff0000, v11
    v_and_b32 v11, 0xffff, v11
    v_and_b32 v17, 0xffff0000, v12
    v_and_b32 v12, 0xffff, v12
    v_and_b32 v18, 0xffff0000, v13
    v_and_b32 v13, 0xffff, v13
    v_and_b32 v19, 0xffff0000, v14
    v_and_b32 v14, 0xffff, v14
    v_dot2_f32_bf16 v40, v20, v10, v40
    v_dot2_f32_bf16 v41, v20, v15, v41
    v_dot2_f32_bf16 v42, v21, v10, v42
    v_dot2_f32_bf16 v43, v21, v15, v43
    v_dot2_f32_bf16 v44, v22, v10, v44
    v_dot2_f32_bf16 v45, v22, v15, v45
    v_dot2_f32_bf16 v46, v23, v10, v46
    v_dot2_f32_bf16 v47, v23, v15, v47
    v_dot2_f32_bf16 v40, v24, v11, v40
    v_dot2_f32_bf16 v41, v24, v16, v41
    v_dot2_f32_bf16 v42, v25, v11, v42
    v_dot2_f32_bf16 v43, v25, v16, v43
    v_dot2_f32_bf16 v44, v26, v11, v44
    v_dot2_f32_bf16 v45, v26, v16, v45
    v_dot2_f32_bf16 v46, v27, v11, v46
    v_dot2_f32_bf16 v47, v27, v16, v47
    v_dot2_f32_bf16 v40, v28, v12, v40
    v_dot2_f32_bf16 v41, v28, v17, v41
    v_dot2_f32_bf16 v42, v29, v12, v42
    v_dot2_f32_bf16 v43, v29, v17, v43
    v_dot2_f32_bf16 v44, v30, v12, v44
    v_dot2_f32_bf16 v45, v30, v17, v45
    v_dot2_f32_bf16 v46, v31, v12, v46
    v_dot2_f32_bf16 v47, v31, v17, v47
    v_dot2_f32_bf16 v40, v32, v13, v40
    v_dot2_f32_bf16 v41, v32, v18, v41
    v_dot2_f32_bf16 v42, v33, v13, v42
    v_dot2_f32_bf16 v43, v33, v18, v43
    v_dot2_f32_bf16 v44, v34, v13, v44
    v_dot2_f32_bf16 v45, v34, v18, v45
    v_dot2_f32_bf16 v46, v35, v13, v46
    v_dot2_f32_bf16 v47, v35, v18, v47
    v_dot2_f32_bf16 v40, v36, v14, v40
    v_dot2_f32_bf16 v41, v36, v19, v41
    v_dot2_f32_bf16 v42, v37, v14, v42
    v_dot2_f32_bf16 v43, v37, v19, v43
    v_dot2_f32_bf16 v44, v38, v14, v44
    v_dot2_f32_bf16 v45, v38, v19, v45
    v_dot2_f32_bf16 v46, v39, v14, v46
    v_dot2_f32_bf16 v47, v39, v19, v47
    v_lshlrev_b32 v6, 5, v0
    ds_write_b128 v6, v[40:43]
    s_nop 0
    ds_write_b128 v6, v[44:47] offset:16
    s_waitcnt lgkmcnt(0)
    s_barrier
    s_cmp_lg_u32 s3, 0
    s_cbranch_scc1 K0_END
    v_lshlrev_b32 v6, 2, v1
    ds_read2st64_b32 v[10:11], v6 offset0:0 offset1:1
    ds_read2st64_b32 v[12:13], v6 offset0:2 offset1:3
    ds_read2st64_b32 v[14:15], v6 offset0:4 offset1:5
    ds_read2st64_b32 v[16:17], v6 offset0:6 offset1:7
    ds_read2st64_b32 v[18:19], v6 offset0:8 offset1:9
    ds_read2st64_b32 v[20:21], v6 offset0:10 offset1:11
    ds_read2st64_b32 v[22:23], v6 offset0:12 offset1:13
    ds_read2st64_b32 v[24:25], v6 offset0:14 offset1:15
    ds_read2st64_b32 v[26:27], v6 offset0:16 offset1:17
    ds_read2st64_b32 v[28:29], v6 offset0:18 offset1:19
    ds_read2st64_b32 v[30:31], v6 offset0:20 offset1:21
    ds_read2st64_b32 v[32:33], v6 offset0:22 offset1:23
    ds_read2st64_b32 v[34:35], v6 offset0:24 offset1:25
    ds_read2st64_b32 v[36:37], v6 offset0:26 offset1:27
    ds_read2st64_b32 v[38:39], v6 offset0:28 offset1:29
    ds_read2st64_b32 v[40:41], v6 offset0:30 offset1:31
    s_waitcnt lgkmcnt(0)
    v_add_f32 v10, v10, v26
    v_add_f32 v11, v11, v27
    v_add_f32 v12, v12, v28
    v_add_f32 v13, v13, v29
    v_add_f32 v14, v14, v30
    v_add_f32 v15, v15, v31
    v_add_f32 v16, v16, v32
    v_add_f32 v17, v17, v33
    v_add_f32 v18, v18, v34
    v_add_f32 v19, v19, v35
    v_add_f32 v20, v20, v36
    v_add_f32 v21, v21, v37
    v_add_f32 v22, v22, v38
    v_add_f32 v23, v23, v39
    v_add_f32 v24, v24, v40
    v_add_f32 v25, v25, v41
    v_add_f32 v10, v10, v18
    v_add_f32 v11, v11, v19
    v_add_f32 v12, v12, v20
    v_add_f32 v13, v13, v21
    v_add_f32 v14, v14, v22
    v_add_f32 v15, v15, v23
    v_add_f32 v16, v16, v24
    v_add_f32 v17, v17, v25
    v_add_f32 v10, v10, v14
    v_add_f32 v11, v11, v15
    v_add_f32 v12, v12, v16
    v_add_f32 v13, v13, v17
    v_add_f32 v10, v10, v12
    v_add_f32 v11, v11, v13
    v_add_f32 v10, v10, v11
    s_mul_i32 s42, s40, 15360
    s_lshl_b32 s43, s41, 8
    s_add_u32 s42, s42, s43
    s_add_u32 s42, s42, 0
    buffer_store_dword v10, v6, s[12:15], s42 offen
    s_waitcnt vmcnt(0)
    s_endpgm
K0_NOTMOD:
    s_cmp_ge_u32 s2, 208
    s_cbranch_scc1 K0_NOTLN
    s_sub_u32 s40, s2, 80
    s_mov_b32 s8, s24
    s_and_b32 s9, s25, 0xffff
    s_mov_b32 s10, 2621440
    s_mov_b32 s11, 0x00020000
    v_lshrrev_b32 v2, 4, v0
    v_and_b32 v3, 15, v0
    v_mul_u32_u24 v4, 1280, v2
    v_lshl_add_u32 v4, v3, 4, v4
    s_mul_i32 s41, s40, 20480
    buffer_load_dwordx4 v[20:23], v4, s[8:11], s41 offen offset:0
    buffer_load_dwordx4 v[24:27], v4, s[8:11], s41 offen offset:256
    buffer_load_dwordx4 v[28:31], v4, s[8:11], s41 offen offset:512
    buffer_load_dwordx4 v[32:35], v4, s[8:11], s41 offen offset:768
    buffer_load_dwordx4 v[36:39], v4, s[8:11], s41 offen offset:1024
    s_mov_b32 s42, 0x3f803f80
    s_mov_b32 s43, 0x00003f80
    s_mov_b32 s44, 0x3f800000
    v_mov_b32 v10, 0
    v_lshrrev_b32 v5, 2, v3
    v_and_b32 v6, 3, v3
    v_lshlrev_b32 v5, 10, v5
    v_lshl_add_u32 v5, v6, 8, v5
    v_lshl_add_u32 v5, v2, 4, v5
    s_mul_i32 s45, s40, 20480
    s_add_u32 s45, s45, 9437184
    v_mov_b32 v84, 0
    v_mov_b32 v85, 0
    v_mov_b32 v86, 0
    v_mov_b32 v87, 0
    v_lshlrev_b32 v88, 4, v0
    s_lshl_b32 s46, s40, 12
    s_add_u32 s46, s46, 29360128
    v_lshlrev_b32 v89, 7, v0
    v_mov_b32 v90, 0x40000000
    v_cmp_gt_u32 vcc, 26, v0
    s_nop 1
    v_cndmask_b32 v89, v90, v89, vcc
    s_mul_i32 s47, s40, 3328
    s_add_u32 s47, s47, 524288
    s_waitcnt vmcnt(4)
    v_dot2_f32_bf16 v10, v20, s42, v10
    v_dot2_f32_bf16 v10, v21, s42, v10
    v_dot2_f32_bf16 v10, v22, s42, v10
    v_dot2_f32_bf16 v10, v23, s42, v10
    s_waitcnt vmcnt(3)
    v_dot2_f32_bf16 v10, v24, s42, v10
    v_dot2_f32_bf16 v10, v25, s42, v10
    v_dot2_f32_bf16 v10, v26, s42, v10
    v_dot2_f32_bf16 v10, v27, s42, v10
    s_waitcnt vmcnt(2)
    v_dot2_f32_bf16 v10, v28, s42, v10
    v_dot2_f32_bf16 v10, v29, s42, v10
    v_dot2_f32_bf16 v10, v30, s42, v10
    v_dot2_f32_bf16 v10, v31, s42, v10
    s_waitcnt vmcnt(1)
    v_dot2_f32_bf16 v10, v32, s42, v10
    v_dot2_f32_bf16 v10, v33, s42, v10
    v_dot2_f32_bf16 v10, v34, s42, v10
    v_dot2_f32_bf16 v10, v35, s42, v10
    s_waitcnt vmcnt(0)
    v_dot2_f32_bf16 v10, v36, s42, v10
    v_dot2_f32_bf16 v10, v37, s42, v10
    v_dot2_f32_bf16 v10, v38, s42, v10
    v_dot2_f32_bf16 v10, v39, s42, v10
    buffer_store_dwordx4 v[84:87], v88, s[12:15], s46 offen
    buffer_store_dword v84, v89, s[12:15], s47 offen
    s_nop 0
    v_add_f32_dpp v10, v10, v10 row_ror:8 row_mask:0xf bank_mask:0xf
    s_nop 1
    v_add_f32_dpp v10, v10, v10 row_ror:4 row_mask:0xf bank_mask:0xf
    s_nop 1
    v_add_f32_dpp v10, v10, v10 row_ror:2 row_mask:0xf bank_mask:0xf
    s_nop 1
    v_add_f32_dpp v10, v10, v10 row_ror:1 row_mask:0xf bank_mask:0xf
    v_mul_f32 v10, 0x3acccccd, v10
    v_cvt_pk_bf16_f32 v11, v10, v10
    v_and_b32 v11, 0xffff0000, v11
    v_sub_f32 v12, v10, v11
    v_sub_f32 v11, 0, v11
    v_dot2_f32_bf16 v40, v20, s43, v11
    v_dot2_f32_bf16 v41, v20, s44, v11
    v_dot2_f32_bf16 v42, v21, s43, v11
    v_dot2_f32_bf16 v43, v21, s44, v11
    v_dot2_f32_bf16 v44, v22, s43, v11
    v_dot2_f32_bf16 v45, v22, s44, v11
    v_dot2_f32_bf16 v46, v23, s43, v11
    v_dot2_f32_bf16 v47, v23, s44, v11
    v_dot2_f32_bf16 v48, v24, s43, v11
    v_dot2_f32_bf16 v49, v24, s44, v11
    v_dot2_f32_bf16 v50, v25, s43, v11
    v_dot2_f32_bf16 v51, v25, s44, v11
    v_dot2_f32_bf16 v52, v26, s43, v11
    v_dot2_f32_bf16 v53, v26, s44, v11
    v_dot2_f32_bf16 v54, v27, s43, v11
    v_dot2_f32_bf16 v55, v27, s44, v11
    v_dot2_f32_bf16 v56, v28, s43, v11
    v_dot2_f32_bf16 v57, v28, s44, v11
    v_dot2_f32_bf16 v58, v29, s43, v11
    v_dot2_f32_bf16 v59, v29, s44, v11
    v_dot2_f32_bf16 v60, v30, s43, v11
    v_dot2_f32_bf16 v61, v30, s44, v11
    v_dot2_f32_bf16 v62, v31, s43, v11
    v_dot2_f32_bf16 v63, v31, s44, v11
    v_dot2_f32_bf16 v64, v32, s43, v11
    v_dot2_f32_bf16 v65, v32, s44, v11
    v_dot2_f32_bf16 v66, v33, s43, v11
    v_dot2_f32_bf16 v67, v33, s44, v11
    v_dot2_f32_bf16 v68, v34, s43, v11
    v_dot2_f32_bf16 v69, v34, s44, v11
    v_dot2_f32_bf16 v70, v35, s43, v11
    v_dot2_f32_bf16 v71, v35, s44, v11
    v_dot2_f32_bf16 v72, v36, s43, v11
    v_dot2_f32_bf16 v73, v36, s44, v11
    v_dot2_f32_bf16 v74, v37, s43, v11
    v_dot2_f32_bf16 v75, v37, s44, v11
    v_dot2_f32_bf16 v76, v38, s43, v11
    v_dot2_f32_bf16 v77, v38, s44, v11
    v_dot2_f32_bf16 v78, v39, s43, v11
    v_dot2_f32_bf16 v79, v39, s44, v11
    v_mul_f32 v13, v40, v40
    v_mul_f32 v14, v41, v41
    v_fmac_f32 v13, v42, v42
    v_fmac_f32 v14, v43, v43
    v_fmac_f32 v13, v44, v44
    v_fmac_f32 v14, v45, v45
    v_fmac_f32 v13, v46, v46
    v_fmac_f32 v14, v47, v47
    v_fmac_f32 v13, v48, v48
    v_fmac_f32 v14, v49, v49
    v_fmac_f32 v13, v50, v50
    v_fmac_f32 v14, v51, v51
    v_fmac_f32 v13, v52, v52
    v_fmac_f32 v14, v53, v53
    v_fmac_f32 v13, v54, v54
    v_fmac_f32 v14, v55, v55
    v_fmac_f32 v13, v56, v56
    v_fmac_f32 v14, v57, v57
    v_fmac_f32 v13, v58, v58
    v_fmac_f32 v14, v59, v59
    v_fmac_f32 v13, v60, v60
    v_fmac_f32 v14, v61, v61
    v_fmac_f32 v13, v62, v62
    v_fmac_f32 v14, v63, v63
    v_fmac_f32 v13, v64, v64
    v_fmac_f32 v14, v65, v65
    v_fmac_f32 v13, v66, v66
    v_fmac_f32 v14, v67, v67
    v_fmac_f32 v13, v68, v68
    v_fmac_f32 v14, v69, v69
    v_fmac_f32 v13, v70, v70
    v_fmac_f32 v14, v71, v71
    v_fmac_f32 v13, v72, v72
    v_fmac_f32 v14, v73, v73
    v_fmac_f32 v13, v74, v74
    v_fmac_f32 v14, v75, v75
    v_fmac_f32 v13, v76, v76
    v_fmac_f32 v14, v77, v77
    v_fmac_f32 v13, v78, v78
    v_fmac_f32 v14, v79, v79
    v_add_f32 v13, v13, v14
    s_nop 1
    v_add_f32_dpp v13, v13, v13 row_ror:8 row_mask:0xf bank_mask:0xf
    s_nop 1
    v_add_f32_dpp v13, v13, v13 row_ror:4 row_mask:0xf bank_mask:0xf
    s_nop 1
    v_add_f32_dpp v13, v13, v13 row_ror:2 row_mask:0xf bank_mask:0xf
    s_nop 1
    v_add_f32_dpp v13, v13, v13 row_ror:1 row_mask:0xf bank_mask:0xf
    v_mul_f32 v13, 0x3acccccd, v13
    v_fma_f32 v13, -v12, v12, v13
    v_max_f32 v13, 0, v13
    v_cvt_pk_bf16_f32 v13, v13, v13
    v_and_b32 v13, 0xffff0000, v13
    v_add_f32 v13, 0x3727c5ac, v13
    v_cvt_pk_bf16_f32 v13, v13, v13
    v_and_b32 v13, 0xffff0000, v13
    v_sqrt_f32 v13, v13
    s_nop 0
    v_cvt_pk_bf16_f32 v13, v13, v13
    v_and_b32 v13, 0xffff0000, v13
    v_rcp_f32 v13, v13
    s_nop 0
    v_mul_f32 v40, v40, v13
    v_mul_f32 v41, v41, v13
    v_mul_f32 v42, v42, v13
    v_mul_f32 v43, v43, v13
    v_mul_f32 v44, v44, v13
    v_mul_f32 v45, v45, v13
    v_mul_f32 v46, v46, v13
    v_mul_f32 v47, v47, v13
    v_cvt_pk_bf16_f32 v20, v40, v41
    v_cvt_pk_bf16_f32 v21, v42, v43
    v_cvt_pk_bf16_f32 v22, v44, v45
    v_cvt_pk_bf16_f32 v23, v46, v47
    buffer_store_dwordx4 v[20:23], v5, s[12:15], s45 offen
    s_add_u32 s45, s45, 4096
    v_mul_f32 v48, v48, v13
    v_mul_f32 v49, v49, v13
    v_mul_f32 v50, v50, v13
    v_mul_f32 v51, v51, v13
    v_mul_f32 v52, v52, v13
    v_mul_f32 v53, v53, v13
    v_mul_f32 v54, v54, v13
    v_mul_f32 v55, v55, v13
    v_cvt_pk_bf16_f32 v24, v48, v49
    v_cvt_pk_bf16_f32 v25, v50, v51
    v_cvt_pk_bf16_f32 v26, v52, v53
    v_cvt_pk_bf16_f32 v27, v54, v55
    buffer_store_dwordx4 v[24:27], v5, s[12:15], s45 offen
    s_add_u32 s45, s45, 4096
    v_mul_f32 v56, v56, v13
    v_mul_f32 v57, v57, v13
    v_mul_f32 v58, v58, v13
    v_mul_f32 v59, v59, v13
    v_mul_f32 v60, v60, v13
    v_mul_f32 v61, v61, v13
    v_mul_f32 v62, v62, v13
    v_mul_f32 v63, v63, v13
    v_cvt_pk_bf16_f32 v28, v56, v57
    v_cvt_pk_bf16_f32 v29, v58, v59
    v_cvt_pk_bf16_f32 v30, v60, v61
    v_cvt_pk_bf16_f32 v31, v62, v63
    buffer_store_dwordx4 v[28:31], v5, s[12:15], s45 offen
    s_add_u32 s45, s45, 4096
    v_mul_f32 v64, v64, v13
    v_mul_f32 v65, v65, v13
    v_mul_f32 v66, v66, v13
    v_mul_f32 v67, v67, v13
    v_mul_f32 v68, v68, v13
    v_mul_f32 v69, v69, v13
    v_mul_f32 v70, v70, v13
    v_mul_f32 v71, v71, v13
    v_cvt_pk_bf16_f32 v32, v64, v65
    v_cvt_pk_bf16_f32 v33, v66, v67
    v_cvt_pk_bf16_f32 v34, v68, v69
    v_cvt_pk_bf16_f32 v35, v70, v71
    buffer_store_dwordx4 v[32:35], v5, s[12:15], s45 offen
    s_add_u32 s45, s45, 4096
    v_mul_f32 v72, v72, v13
    v_mul_f32 v73, v73, v13
    v_mul_f32 v74, v74, v13
    v_mul_f32 v75, v75, v13
    v_mul_f32 v76, v76, v13
    v_mul_f32 v77, v77, v13
    v_mul_f32 v78, v78, v13
    v_mul_f32 v79, v79, v13
    v_cvt_pk_bf16_f32 v36, v72, v73
    v_cvt_pk_bf16_f32 v37, v74, v75
    v_cvt_pk_bf16_f32 v38, v76, v77
    v_cvt_pk_bf16_f32 v39, v78, v79
    buffer_store_dwordx4 v[36:39], v5, s[12:15], s45 offen
    s_endpgm
K0_NOTLN:
    s_cmp_ge_u32 s2, 258
    s_cbranch_scc1 K0_KVJOB
    s_sub_u32 s50, s2, 208
    s_lshl_b32 s50, s50, 2
    s_add_u32 s50, s50, s3
    s_lshl_b32 s53, s3, 12
    s_mov_b32 s8, s26
    s_and_b32 s9, s27, 0xffff
    s_mov_b32 s10, 819200
    s_mov_b32 s11, 0x00020000
    s_mul_i32 s51, s50, 205
    s_lshr_b32 s51, s51, 11
    s_mul_i32 s52, s51, 10
    s_sub_u32 s52, s50, s52
    v_lshrrev_b32 v2, 3, v1
    v_and_b32 v3, 7, v1
    v_mul_u32_u24 v2, 1280, v2
    v_lshl_add_u32 v2, v3, 4, v2
    s_mul_i32 s40, s51, 40960
    s_lshl_b32 s41, s52, 7
    s_add_u32 s40, s40, s41
    s_mov_b32 s41, s53
    s_mov_b32 m0, s41
    s_nop 0
    buffer_load_dwordx4 v2, s[8:11], s40 offen lds
    s_add_u32 s40, s40, 10240
    s_add_u32 s41, s41, 1024
    s_mov_b32 m0, s41
    s_nop 0
    buffer_load_dwordx4 v2, s[8:11], s40 offen lds
    s_add_u32 s40, s40, 10240
    s_add_u32 s41, s41, 1024
    s_mov_b32 m0, s41
    s_nop 0
    buffer_load_dwordx4 v2, s[8:11], s40 offen lds
    s_add_u32 s40, s40, 10240
    s_add_u32 s41, s41, 1024
    s_mov_b32 m0, s41
    s_nop 0
    buffer_load_dwordx4 v2, s[8:11], s40 offen lds
    v_lshrrev_b32 v4, 4, v1
    v_bfe_u32 v5, v1, 2, 2
    v_and_b32 v6, 3, v1
    v_lshl_add_u32 v7, v4, 3, v5
    v_lshlrev_b32 v7, 7, v7
    v_lshl_add_u32 v7, v6, 3, v7
    v_add_u32 v7, s53, v7
    v_lshlrev_b32 v8, 4, v1
    s_mul_i32 s42, s52, 81920
    s_mul_i32 s43, s51, 1024
    s_add_u32 s42, s42, s43
    s_add_u32 s42, s42, 1048576
    s_waitcnt vmcnt(0)
    ds_read_b64_tr_b16 v[12:13], v7 offset:0
    ds_read_b64_tr_b16 v[14:15], v7 offset:512
    s_waitcnt lgkmcnt(0)
    buffer_store_dwordx4 v[12:15], v8, s[12:15], s42 offen offset:0
    s_add_u32 s42, s42, 20480
    ds_read_b64_tr_b16 v[16:17], v7 offset:32
    ds_read_b64_tr_b16 v[18:19], v7 offset:544
    s_waitcnt lgkmcnt(0)
    buffer_store_dwordx4 v[16:19], v8, s[12:15], s42 offen offset:0
    s_add_u32 s42, s42, 20480
    ds_read_b64_tr_b16 v[20:21], v7 offset:64
    ds_read_b64_tr_b16 v[22:23], v7 offset:576
    s_waitcnt lgkmcnt(0)
    buffer_store_dwordx4 v[20:23], v8, s[12:15], s42 offen offset:0
    s_add_u32 s42, s42, 20480
    ds_read_b64_tr_b16 v[24:25], v7 offset:96
    ds_read_b64_tr_b16 v[26:27], v7 offset:608
    s_waitcnt lgkmcnt(0)
    buffer_store_dwordx4 v[24:27], v8, s[12:15], s42 offen offset:0
    s_endpgm
K0_KVJOB:
    s_cmp_lt_u32 s2, 278
    s_cbranch_scc1 K0_KVJOB2
    s_sub_u32 s50, s2, 278
    s_lshl_b32 s50, s50, 2
    s_add_u32 s50, s50, s3
    s_lshl_b32 s53, s3, 12
    s_mov_b32 s8, s32
    s_and_b32 s9, s33, 0xffff
    s_mov_b32 s10, 819200
    s_mov_b32 s11, 0x00020000
    s_mul_i32 s51, s50, 205
    s_lshr_b32 s51, s51, 11
    s_mul_i32 s52, s51, 10
    s_sub_u32 s52, s50, s52
    v_lshrrev_b32 v2, 3, v1
    v_and_b32 v3, 7, v1
    v_mul_u32_u24 v2, 1280, v2
    v_lshl_add_u32 v2, v3, 4, v2
    s_mul_i32 s40, s51, 40960
    s_lshl_b32 s41, s52, 7
    s_add_u32 s40, s40, s41
    s_mov_b32 s41, s53
    s_mov_b32 m0, s41
    s_nop 0
    buffer_load_dwordx4 v2, s[8:11], s40 offen lds
    s_add_u32 s40, s40, 10240
    s_add_u32 s41, s41, 1024
    s_mov_b32 m0, s41
    s_nop 0
    buffer_load_dwordx4 v2, s[8:11], s40 offen lds
    s_add_u32 s40, s40, 10240
    s_add_u32 s41, s41, 1024
    s_mov_b32 m0, s41
    s_nop 0
    buffer_load_dwordx4 v2, s[8:11], s40 offen lds
    s_add_u32 s40, s40, 10240
    s_add_u32 s41, s41, 1024
    s_mov_b32 m0, s41
    s_nop 0
    buffer_load_dwordx4 v2, s[8:11], s40 offen lds
    v_lshrrev_b32 v4, 4, v1
    v_bfe_u32 v5, v1, 2, 2
    v_and_b32 v6, 3, v1
    v_lshl_add_u32 v7, v4, 3, v5
    v_lshlrev_b32 v7, 7, v7
    v_lshl_add_u32 v7, v6, 3, v7
    v_add_u32 v7, s53, v7
    v_lshlrev_b32 v8, 4, v1
    s_mul_i32 s42, s52, 81920
    s_mul_i32 s43, s51, 1024
    s_add_u32 s42, s42, s43
    s_add_u32 s42, s42, 2097152
    s_waitcnt vmcnt(0)
    ds_read_b64_tr_b16 v[12:13], v7 offset:0
    ds_read_b64_tr_b16 v[14:15], v7 offset:512
    s_waitcnt lgkmcnt(0)
    buffer_store_dwordx4 v[12:15], v8, s[12:15], s42 offen offset:0
    s_add_u32 s42, s42, 20480
    ds_read_b64_tr_b16 v[16:17], v7 offset:32
    ds_read_b64_tr_b16 v[18:19], v7 offset:544
    s_waitcnt lgkmcnt(0)
    buffer_store_dwordx4 v[16:19], v8, s[12:15], s42 offen offset:0
    s_add_u32 s42, s42, 20480
    ds_read_b64_tr_b16 v[20:21], v7 offset:64
    ds_read_b64_tr_b16 v[22:23], v7 offset:576
    s_waitcnt lgkmcnt(0)
    buffer_store_dwordx4 v[20:23], v8, s[12:15], s42 offen offset:0
    s_add_u32 s42, s42, 20480
    ds_read_b64_tr_b16 v[24:25], v7 offset:96
    ds_read_b64_tr_b16 v[26:27], v7 offset:608
    s_waitcnt lgkmcnt(0)
    buffer_store_dwordx4 v[24:27], v8, s[12:15], s42 offen offset:0
    s_endpgm
K0_KVJOB2:
    s_sub_u32 s50, s2, 258
    s_lshl_b32 s50, s50, 2
    s_add_u32 s50, s50, s3
    s_mul_i32 s51, s50, 103
    s_lshr_b32 s51, s51, 11
    s_mul_i32 s52, s51, 20
    s_sub_u32 s52, s50, s52
    s_cmp_ge_u32 s51, 2
    s_cselect_b32 s8, s30, s28
    s_cselect_b32 s9, s31, s29
    s_and_b32 s9, s9, 0xffff
    s_mov_b32 s10, 25600
    s_mov_b32 s11, 0x00020000
    s_and_b32 s53, s51, 1
    s_lshl_b32 s53, s53, 4
    v_and_b32 v2, 15, v1
    v_add_u32 v2, s53, v2
    v_lshrrev_b32 v3, 4, v1
    v_mul_u32_u24 v3, 320, v3
    v_lshl_add_u32 v3, v2, 1, v3
    v_mov_b32 v4, 0x40000000
    v_cmp_gt_u32 vcc, 20, v2
    s_nop 1
    v_cndmask_b32 v3, v4, v3, vcc
    s_mul_i32 s54, s52, 1280
    buffer_load_ushort v20, v3, s[8:11], s54 offen offset:0
    buffer_load_ushort v21, v3, s[8:11], s54 offen offset:40
    buffer_load_ushort v22, v3, s[8:11], s54 offen offset:80
    buffer_load_ushort v23, v3, s[8:11], s54 offen offset:120
    buffer_load_ushort v24, v3, s[8:11], s54 offen offset:160
    buffer_load_ushort v25, v3, s[8:11], s54 offen offset:200
    buffer_load_ushort v26, v3, s[8:11], s54 offen offset:240
    buffer_load_ushort v27, v3, s[8:11], s54 offen offset:280
    v_lshlrev_b32 v5, 4, v1
    s_lshl_b32 s55, s50, 10
    s_add_u32 s55, s55, 1867776
    s_waitcnt vmcnt(0)
    v_lshl_or_b32 v10, v21, 16, v20
    v_lshl_or_b32 v11, v23, 16, v22
    v_lshl_or_b32 v12, v25, 16, v24
    v_lshl_or_b32 v13, v27, 16, v26
    buffer_store_dwordx4 v[10:13], v5, s[12:15], s55 offen
K0_END:
    s_endpgm
.globl main_kernel
.p2align 8
.type main_kernel,@function
main_kernel:
    s_cmp_ge_u32 s2, 256
    s_cbranch_scc1 M_END
    s_load_dwordx2 s[4:5], s[0:1], 112
    s_load_dwordx2 s[52:53], s[0:1], 48
    s_load_dwordx2 s[54:55], s[0:1], 64
    s_load_dwordx2 s[92:93], s[0:1], 0
    v_and_b32 v1, 63, v0
    v_lshrrev_b32 v124, 6, v0
    v_lshlrev_b32 v2, 4, v1
    s_and_b32 s20, s2, 7
    s_bfe_u32 s21, s2, 0x30003
    s_lshr_b32 s22, s2, 6
    s_lshl_b32 s20, s20, 2
    s_add_u32 s20, s20, s22
    s_getreg_b32 s90, hwreg(HW_REG_XCC_ID)
    s_and_b32 s90, s90, 15
    s_add_u32 s90, s90, 1
    v_readfirstlane_b32 s3, v124
    s_cmp_ge_u32 s3, 4
    s_cbranch_scc1 Q_LOADER
    v_lshlrev_b32 v10, 4, v0
    v_lshrrev_b32 v6, 4, v1
    v_lshlrev_b32 v7, 5, v6
    v_add_u32 v7, 149504, v7
    v_add_u32 v8, 149504, v10
    s_lshl_b32 s22, s20, 2
    s_and_b32 s23, s21, 3
    s_add_u32 s22, s22, s23
    s_lshr_b32 s23, s21, 2
    s_mul_i32 s24, s22, 20480
    s_mul_i32 s25, s3, 5120
    s_add_u32 s24, s24, s25
    s_add_u32 s24, s24, 9437184
    s_mul_i32 s26, s23, 40960
    s_add_u32 s26, s26, s25
    s_add_u32 s26, s26, 1867776
    s_add_u32 s27, s26, 20480
    v_add_u32 v11, 4096, v2
    s_waitcnt lgkmcnt(0)
    s_mov_b32 s12, s4
    s_and_b32 s13, s5, 0xffff
    s_mov_b32 s14, 268435456
    s_mov_b32 s15, 0x00020000
    s_mov_b32 s30, 0
    buffer_load_dwordx4 v[140:143], v10, s[12:15], s30 offen
    buffer_load_dwordx4 v[156:159], v10, s[12:15], s30 offen offset:2560
    s_mov_b32 s30, 15360
    buffer_load_dwordx4 v[144:147], v10, s[12:15], s30 offen
    buffer_load_dwordx4 v[160:163], v10, s[12:15], s30 offen offset:2560
    s_mov_b32 s30, 30720
    buffer_load_dwordx4 v[148:151], v10, s[12:15], s30 offen
    buffer_load_dwordx4 v[164:167], v10, s[12:15], s30 offen offset:2560
    s_mov_b32 s30, 46080
    buffer_load_dwordx4 v[152:155], v10, s[12:15], s30 offen
    buffer_load_dwordx4 v[168:171], v10, s[12:15], s30 offen offset:2560
    buffer_load_dwordx4 v[16:19], v2, s[12:15], s24 offen offset:0
    buffer_load_dwordx4 v[36:39], v2, s[12:15], s26 offen offset:0
    buffer_load_dwordx4 v[40:43], v2, s[12:15], s27 offen offset:0
    buffer_load_dwordx4 v[20:23], v2, s[12:15], s24 offen offset:1024
    buffer_load_dwordx4 v[44:47], v2, s[12:15], s26 offen offset:1024
    buffer_load_dwordx4 v[48:51], v2, s[12:15], s27 offen offset:1024
    buffer_load_dwordx4 v[24:27], v2, s[12:15], s24 offen offset:2048
    buffer_load_dwordx4 v[52:55], v2, s[12:15], s26 offen offset:2048
    buffer_load_dwordx4 v[56:59], v2, s[12:15], s27 offen offset:2048
    buffer_load_dwordx4 v[28:31], v2, s[12:15], s24 offen offset:3072
    buffer_load_dwordx4 v[60:63], v2, s[12:15], s26 offen offset:3072
    buffer_load_dwordx4 v[64:67], v2, s[12:15], s27 offen offset:3072
    buffer_load_dwordx4 v[32:35], v11, s[12:15], s24 offen offset:0
    buffer_load_dwordx4 v[68:71], v11, s[12:15], s26 offen offset:0
    buffer_load_dwordx4 v[72:75], v11, s[12:15], s27 offen offset:0
    s_waitcnt vmcnt(15)
    v_add_f32 v140, v140, v144
    v_add_f32 v148, v148, v152
    v_add_f32 v156, v156, v160
    v_add_f32 v164, v164, v168
    v_add_f32 v141, v141, v145
    v_add_f32 v149, v149, v153
    v_add_f32 v157, v157, v161
    v_add_f32 v165, v165, v169
    v_add_f32 v142, v142, v146
    v_add_f32 v150, v150, v154
    v_add_f32 v158, v158, v162
    v_add_f32 v166, v166, v170
    v_add_f32 v143, v143, v147
    v_add_f32 v151, v151, v155
    v_add_f32 v159, v159, v163
    v_add_f32 v167, v167, v171
    v_add_f32 v140, v140, v148
    v_add_f32 v156, v156, v164
    v_add_f32 v141, v141, v149
    v_add_f32 v157, v157, v165
    v_add_f32 v142, v142, v150
    v_add_f32 v158, v158, v166
    v_add_f32 v143, v143, v151
    v_add_f32 v159, v159, v167
    v_cvt_pk_bf16_f32 v140, v140, v140
    v_and_b32 v140, 0xffff0000, v140
    v_cvt_pk_bf16_f32 v156, v156, v156
    v_and_b32 v156, 0xffff0000, v156
    v_cvt_pk_bf16_f32 v141, v141, v141
    v_and_b32 v141, 0xffff0000, v141
    v_cvt_pk_bf16_f32 v157, v157, v157
    v_and_b32 v157, 0xffff0000, v157
    v_cvt_pk_bf16_f32 v142, v142, v142
    v_and_b32 v142, 0xffff0000, v142
    v_cvt_pk_bf16_f32 v158, v158, v158
    v_and_b32 v158, 0xffff0000, v158
    v_cvt_pk_bf16_f32 v143, v143, v143
    v_and_b32 v143, 0xffff0000, v143
    v_cvt_pk_bf16_f32 v159, v159, v159
    v_and_b32 v159, 0xffff0000, v159
    v_add_f32 v156, 1.0, v156
    v_add_f32 v157, 1.0, v157
    v_add_f32 v158, 1.0, v158
    v_add_f32 v159, 1.0, v159
    v_cvt_pk_bf16_f32 v156, v156, v156
    v_and_b32 v156, 0xffff0000, v156
    v_cvt_pk_bf16_f32 v157, v157, v157
    v_and_b32 v157, 0xffff0000, v157
    v_cvt_pk_bf16_f32 v158, v158, v158
    v_and_b32 v158, 0xffff0000, v158
    v_cvt_pk_bf16_f32 v159, v159, v159
    v_and_b32 v159, 0xffff0000, v159
    v_lshrrev_b32 v156, 16, v156
    v_lshrrev_b32 v158, 16, v158
    v_cmp_gt_u32 vcc, 160, v0
    s_and_saveexec_b64 s[32:33], vcc
    ds_write_b128 v8, v[156:159]
    ds_write_b128 v8, v[140:143] offset:2560
    s_mov_b64 exec, s[32:33]
    s_mul_i32 s25, s3, 640
    v_add_u32 v9, s25, v7
    s_waitcnt lgkmcnt(0)
    s_barrier
    ds_read_b128 v[140:143], v9 offset:0
    ds_read_b128 v[144:147], v9 offset:16
    ds_read_b128 v[148:151], v9 offset:2560
    ds_read_b128 v[152:155], v9 offset:2576
    ds_read_b128 v[156:159], v9 offset:128
    ds_read_b128 v[160:163], v9 offset:144
    ds_read_b128 v[164:167], v9 offset:2688
    ds_read_b128 v[168:171], v9 offset:2704
    ds_read_b128 v[172:175], v9 offset:256
    ds_read_b128 v[176:179], v9 offset:272
    ds_read_b128 v[180:183], v9 offset:2816
    ds_read_b128 v[184:187], v9 offset:2832
    s_waitcnt vmcnt(0)
    s_waitcnt lgkmcnt(8)
    v_dot2_f32_bf16 v92, v16, v140, v148
    v_dot2_f32_bf16 v93, v16, v141, v149
    v_dot2_f32_bf16 v94, v17, v142, v150
    v_dot2_f32_bf16 v95, v17, v143, v151
    v_dot2_f32_bf16 v96, v18, v144, v152
    v_dot2_f32_bf16 v97, v18, v145, v153
    v_dot2_f32_bf16 v98, v19, v146, v154
    v_dot2_f32_bf16 v99, v19, v147, v155
    ds_read_b128 v[188:191], v9 offset:384
    ds_read_b128 v[192:195], v9 offset:400
    ds_read_b128 v[196:199], v9 offset:2944
    ds_read_b128 v[200:203], v9 offset:2960
    v_cvt_pk_bf16_f32 v16, v92, v93
    v_cvt_pk_bf16_f32 v17, v94, v95
    v_cvt_pk_bf16_f32 v18, v96, v97
    v_cvt_pk_bf16_f32 v19, v98, v99
    s_waitcnt lgkmcnt(8)
    v_dot2_f32_bf16 v92, v20, v156, v164
    v_dot2_f32_bf16 v93, v20, v157, v165
    v_dot2_f32_bf16 v94, v21, v158, v166
    v_dot2_f32_bf16 v95, v21, v159, v167
    v_dot2_f32_bf16 v96, v22, v160, v168
    v_dot2_f32_bf16 v97, v22, v161, v169
    v_dot2_f32_bf16 v98, v23, v162, v170
    v_dot2_f32_bf16 v99, v23, v163, v171
    ds_read_b128 v[204:207], v9 offset:512
    ds_read_b128 v[208:211], v9 offset:528
    ds_read_b128 v[212:215], v9 offset:3072
    ds_read_b128 v[216:219], v9 offset:3088
    v_cvt_pk_bf16_f32 v20, v92, v93
    v_cvt_pk_bf16_f32 v21, v94, v95
    v_cvt_pk_bf16_f32 v22, v96, v97
    v_cvt_pk_bf16_f32 v23, v98, v99
    s_waitcnt lgkmcnt(8)
    v_dot2_f32_bf16 v92, v24, v172, v180
    v_dot2_f32_bf16 v93, v24, v173, v181
    v_dot2_f32_bf16 v94, v25, v174, v182
    v_dot2_f32_bf16 v95, v25, v175, v183
    v_dot2_f32_bf16 v96, v26, v176, v184
    v_dot2_f32_bf16 v97, v26, v177, v185
    v_dot2_f32_bf16 v98, v27, v178, v186
    v_dot2_f32_bf16 v99, v27, v179, v187
    v_cvt_pk_bf16_f32 v24, v92, v93
    v_cvt_pk_bf16_f32 v25, v94, v95
    v_cvt_pk_bf16_f32 v26, v96, v97
    v_cvt_pk_bf16_f32 v27, v98, v99
    s_waitcnt lgkmcnt(4)
    v_dot2_f32_bf16 v92, v28, v188, v196
    v_dot2_f32_bf16 v93, v28, v189, v197
    v_dot2_f32_bf16 v94, v29, v190, v198
    v_dot2_f32_bf16 v95, v29, v191, v199
    v_dot2_f32_bf16 v96, v30, v192, v200
    v_dot2_f32_bf16 v97, v30, v193, v201
    v_dot2_f32_bf16 v98, v31, v194, v202
    v_dot2_f32_bf16 v99, v31, v195, v203
    v_cvt_pk_bf16_f32 v28, v92, v93
    v_cvt_pk_bf16_f32 v29, v94, v95
    v_cvt_pk_bf16_f32 v30, v96, v97
    v_cvt_pk_bf16_f32 v31, v98, v99
    s_waitcnt lgkmcnt(0)
    v_dot2_f32_bf16 v92, v32, v204, v212
    v_dot2_f32_bf16 v93, v32, v205, v213
    v_dot2_f32_bf16 v94, v33, v206, v214
    v_dot2_f32_bf16 v95, v33, v207, v215
    v_dot2_f32_bf16 v96, v34, v208, v216
    v_dot2_f32_bf16 v97, v34, v209, v217
    v_dot2_f32_bf16 v98, v35, v210, v218
    v_dot2_f32_bf16 v99, v35, v211, v219
    v_cvt_pk_bf16_f32 v32, v92, v93
    v_cvt_pk_bf16_f32 v33, v94, v95
    v_cvt_pk_bf16_f32 v34, v96, v97
    v_cvt_pk_bf16_f32 v35, v98, v99
    s_cmp_eq_u32 s23, 0
    s_cbranch_scc0 Q_VM
    v_mfma_f32_16x16x32_bf16 v[108:111], v[36:39], v[16:19], 0
    v_mfma_f32_16x16x32_bf16 v[112:115], v[40:43], v[16:19], 0
    v_mfma_f32_16x16x32_bf16 v[108:111], v[44:47], v[20:23], v[108:111]
    v_mfma_f32_16x16x32_bf16 v[112:115], v[48:51], v[20:23], v[112:115]
    v_mfma_f32_16x16x32_bf16 v[108:111], v[52:55], v[24:27], v[108:111]
    v_mfma_f32_16x16x32_bf16 v[112:115], v[56:59], v[24:27], v[112:115]
    v_mfma_f32_16x16x32_bf16 v[108:111], v[60:63], v[28:31], v[108:111]
    v_mfma_f32_16x16x32_bf16 v[112:115], v[64:67], v[28:31], v[112:115]
    v_mfma_f32_16x16x32_bf16 v[108:111], v[68:71], v[32:35], v[108:111]
    v_mfma_f32_16x16x32_bf16 v[112:115], v[72:75], v[32:35], v[112:115]
    s_branch Q_KVM
Q_VM:
    v_mfma_f32_16x16x32_bf16 v[108:111], v[16:19], v[36:39], 0
    v_mfma_f32_16x16x32_bf16 v[112:115], v[16:19], v[40:43], 0
    v_mfma_f32_16x16x32_bf16 v[108:111], v[20:23], v[44:47], v[108:111]
    v_mfma_f32_16x16x32_bf16 v[112:115], v[20:23], v[48:51], v[112:115]
    v_mfma_f32_16x16x32_bf16 v[108:111], v[24:27], v[52:55], v[108:111]
    v_mfma_f32_16x16x32_bf16 v[112:115], v[24:27], v[56:59], v[112:115]
    v_mfma_f32_16x16x32_bf16 v[108:111], v[28:31], v[60:63], v[108:111]
    v_mfma_f32_16x16x32_bf16 v[112:115], v[28:31], v[64:67], v[112:115]
    v_mfma_f32_16x16x32_bf16 v[108:111], v[32:35], v[68:71], v[108:111]
    v_mfma_f32_16x16x32_bf16 v[112:115], v[32:35], v[72:75], v[112:115]
Q_KVM:
    s_lshl_b32 s25, s3, 11
    v_add_u32 v9, s25, v2
    s_nop 4
    ds_write_b128 v9, v[108:111] offset:0
    ds_write_b128 v9, v[112:115] offset:1024
    s_waitcnt lgkmcnt(0)
    s_barrier
    s_cmp_lg_u32 s3, 3
    s_cbranch_scc1 Q_NOKV
    ds_read_b128 v[16:19], v2 offset:0
    ds_read_b128 v[20:23], v2 offset:1024
    ds_read_b128 v[24:27], v2 offset:2048
    ds_read_b128 v[28:31], v2 offset:3072
    ds_read_b128 v[32:35], v2 offset:4096
    ds_read_b128 v[36:39], v2 offset:5120
    v_and_b32 v9, 15, v1
    s_waitcnt lgkmcnt(0)
    v_pk_add_f32 v[108:109], v[108:109], v[16:17]
    v_pk_add_f32 v[110:111], v[110:111], v[18:19]
    v_pk_add_f32 v[112:113], v[112:113], v[20:21]
    v_pk_add_f32 v[114:115], v[114:115], v[22:23]
    v_pk_add_f32 v[108:109], v[108:109], v[24:25]
    v_pk_add_f32 v[110:111], v[110:111], v[26:27]
    v_pk_add_f32 v[112:113], v[112:113], v[28:29]
    v_pk_add_f32 v[114:115], v[114:115], v[30:31]
    v_pk_add_f32 v[108:109], v[108:109], v[32:33]
    v_pk_add_f32 v[110:111], v[110:111], v[34:35]
    v_pk_add_f32 v[112:113], v[112:113], v[36:37]
    v_pk_add_f32 v[114:115], v[114:115], v[38:39]
    s_cmp_eq_u32 s23, 0
    s_cbranch_scc0 Q_VEPI
    s_lshl_b32 s30, s22, 4
    v_add_u32 v10, s30, v9
    v_cvt_pk_bf16_f32 v12, v108, v109
    v_cvt_pk_bf16_f32 v13, v110, v111
    v_cvt_pk_bf16_f32 v14, v112, v113
    v_cvt_pk_bf16_f32 v15, v114, v115
    v_and_b32 v11, 19, v10
    v_bfe_u32 v17, v10, 2, 1
    v_bfe_u32 v18, v10, 3, 1
    v_lshl_or_b32 v11, v17, 3, v11
    v_lshl_or_b32 v11, v18, 2, v11
    v_lshrrev_b32 v17, 5, v10
    v_mul_u32_u24 v17, 1536, v17
    v_lshl_add_u32 v19, v11, 3, v17
    v_lshl_add_u32 v19, v6, 8, v19
    v_lshl_add_u32 v11, v11, 4, v17
    v_lshrrev_b32 v17, 1, v6
    v_and_b32 v18, 1, v6
    v_lshl_add_u32 v11, v17, 9, v11
    v_lshl_add_u32 v11, v18, 3, v11
    v_dot2_f32_bf16 v16, v12, v12, 0
    v_dot2_f32_bf16 v16, v13, v13, v16
    v_dot2_f32_bf16 v16, v14, v14, v16
    v_dot2_f32_bf16 v16, v15, v15, v16
    s_mov_b32 s30, 131072
    buffer_store_dwordx2 v[12:13], v11, s[12:15], s30 offen sc1
    v_mov_b32 v17, 0x3f803f80
    v_mov_b32 v18, 0x00003f80
    v_cmp_eq_u32 vcc, 1, v6
    s_nop 1
    v_cndmask_b32 v14, v14, v17, vcc
    v_cndmask_b32 v15, v15, v18, vcc
    s_mov_b32 exec_hi, 0
    buffer_store_dwordx2 v[14:15], v19, s[12:15], s30 offen offset:1024 sc1
    s_mov_b64 exec, -1
    v_mov_b32 v20, v16
    s_nop 1
    v_permlane16_swap_b32 v16, v20
    v_add_f32 v16, v16, v20
    v_mov_b32 v20, v16
    s_nop 1
    v_permlane32_swap_b32 v16, v20
    v_add_f32 v16, v16, v20
    s_nop 1
    v_max_f32_dpp v16, v16, v16 row_ror:8 row_mask:0xf bank_mask:0xf
    s_nop 1
    v_max_f32_dpp v16, v16, v16 row_ror:4 row_mask:0xf bank_mask:0xf
    s_nop 1
    v_max_f32_dpp v16, v16, v16 row_ror:2 row_mask:0xf bank_mask:0xf
    s_nop 1
    v_max_f32_dpp v16, v16, v16 row_ror:1 row_mask:0xf bank_mask:0xf
    s_mov_b32 s30, 81920
    s_branch Q_KVST
Q_VEPI:
    v_max3_f32 v16, |v108|, |v109|, |v110|
    v_max3_f32 v16, v16, |v111|, |v112|
    v_max3_f32 v16, v16, |v113|, |v114|
    v_max_f32 v16, v16, |v115|
    v_cvt_pk_bf16_f32 v12, v108, v109
    v_cvt_pk_bf16_f32 v13, v110, v111
    v_cvt_pk_bf16_f32 v14, v112, v113
    v_cvt_pk_bf16_f32 v15, v114, v115
    v_mov_b32 v17, 0x3f803f80
    v_cmp_eq_u32 vcc, 4, v9
    s_nop 1
    v_cndmask_b32 v14, v14, v17, vcc
    v_cndmask_b32 v15, v15, v17, vcc
    v_lshrrev_b32 v17, 1, v6
    v_and_b32 v18, 1, v6
    v_mul_u32_u24 v11, 336, v17
    v_lshl_add_u32 v11, v9, 4, v11
    v_lshl_add_u32 v11, v18, 3, v11
    v_mov_b32 v17, 0x40000000
    v_cmp_gt_u32 vcc, 5, v9
    s_nop 1
    v_cndmask_b32 v19, v17, v11, vcc
    s_mul_i32 s30, s22, 672
    s_add_u32 s30, s30, 229376
    buffer_store_dwordx2 v[12:13], v11, s[12:15], s30 offen sc1
    buffer_store_dwordx2 v[14:15], v19, s[12:15], s30 offen offset:256 sc1
    v_mov_b32 v20, v16
    s_nop 1
    v_permlane16_swap_b32 v16, v20
    v_max_f32 v16, v16, v20
    v_mov_b32 v20, v16
    s_nop 1
    v_permlane32_swap_b32 v16, v20
    v_max_f32 v16, v16, v20
    s_nop 1
    v_max_f32_dpp v16, v16, v16 row_ror:8 row_mask:0xf bank_mask:0xf
    s_nop 1
    v_max_f32_dpp v16, v16, v16 row_ror:4 row_mask:0xf bank_mask:0xf
    s_nop 1
    v_max_f32_dpp v16, v16, v16 row_ror:2 row_mask:0xf bank_mask:0xf
    s_nop 1
    v_max_f32_dpp v16, v16, v16 row_ror:1 row_mask:0xf bank_mask:0xf
    s_mov_b32 s30, 82432
Q_KVST:
    s_lshl_b32 s31, s22, 2
    s_add_u32 s30, s30, s31
    v_mov_b32 v17, 0
    s_mov_b64 exec, 1
    buffer_store_dword v16, v17, s[12:15], s30 offen sc1
    s_mov_b64 exec, -1
Q_NOKV:
    s_lshl_b32 s26, s3, 11
    s_and_b32 s27, s3, 1
    s_lshl_b32 s28, s27, 10
    s_sub_u32 s26, s26, s28
    v_add_u32 v10, s26, v2
    v_add_u32 v13, s28, v2
    s_lshl_b32 s28, s27, 7
    v_add_u32 v9, s28, v7
    s_mov_b32 s56, 47104
    s_mov_b32 s57, 88064
    v_mov_b32 v16, 0
    v_mov_b32 v17, 0
    v_mov_b32 v18, 0
    v_mov_b32 v19, 0
    v_mov_b32 v20, 0
    v_mov_b32 v21, 0
    v_mov_b32 v22, 0
    v_mov_b32 v23, 0
    v_mov_b32 v24, 0
    v_mov_b32 v25, 0
    v_mov_b32 v26, 0
    v_mov_b32 v27, 0
    v_mov_b32 v28, 0
    v_mov_b32 v29, 0
    v_mov_b32 v30, 0
    v_mov_b32 v31, 0
    v_mov_b32 v32, 0
    v_mov_b32 v33, 0
    v_mov_b32 v34, 0
    v_mov_b32 v35, 0
    v_mov_b32 v36, 0
    v_mov_b32 v37, 0
    v_mov_b32 v38, 0
    v_mov_b32 v39, 0
    v_mov_b32 v40, 0
    v_mov_b32 v41, 0
    v_mov_b32 v42, 0
    v_mov_b32 v43, 0
    v_mov_b32 v44, 0
    v_mov_b32 v45, 0
    v_mov_b32 v46, 0
    v_mov_b32 v47, 0
    v_mov_b32 v48, 0
    v_mov_b32 v49, 0
    v_mov_b32 v50, 0
    v_mov_b32 v51, 0
    v_mov_b32 v52, 0
    v_mov_b32 v53, 0
    v_mov_b32 v54, 0
    v_mov_b32 v55, 0
    v_add_u32 v12, s57, v13
    v_add_u32 v11, s56, v10
    s_add_u32 s56, s56, 8192
    s_cmp_ge_u32 s56, 88064
    s_cselect_b32 s56, 47104, s56
    s_add_u32 s57, s57, 10240
    s_cmp_ge_u32 s57, 149504
    s_cselect_b32 s57, 88064, s57
    s_barrier
    ds_read_b128 v[56:59], v11
    ds_read_b128 v[60:63], v11 offset:2048
    ds_read_b128 v[112:115], v9 offset:0
    ds_read_b128 v[116:119], v9 offset:16
    ds_read_b128 v[120:123], v9 offset:2560
    ds_read_b128 v[124:127], v9 offset:2576
    ds_read_b128 v[72:75], v12 offset:0
    ds_read_b128 v[76:79], v12 offset:2048
    ds_read_b128 v[80:83], v12 offset:4096
    ds_read_b128 v[84:87], v12 offset:6144
    ds_read_b128 v[88:91], v12 offset:8192
    v_add_u32 v12, s57, v13
    v_add_u32 v11, s56, v10
    s_add_u32 s56, s56, 8192
    s_cmp_ge_u32 s56, 88064
    s_cselect_b32 s56, 47104, s56
    s_add_u32 s57, s57, 10240
    s_cmp_ge_u32 s57, 149504
    s_cselect_b32 s57, 88064, s57
    s_waitcnt lgkmcnt(5)
    v_dot2_f32_bf16 v128, v56, v112, v120
    v_dot2_f32_bf16 v129, v56, v113, v121
    v_dot2_f32_bf16 v130, v57, v114, v122
    v_dot2_f32_bf16 v131, v57, v115, v123
    v_dot2_f32_bf16 v132, v58, v116, v124
    v_dot2_f32_bf16 v133, v58, v117, v125
    v_dot2_f32_bf16 v134, v59, v118, v126
    v_dot2_f32_bf16 v135, v59, v119, v127
    v_dot2_f32_bf16 v136, v60, v112, v120
    v_dot2_f32_bf16 v137, v60, v113, v121
    v_dot2_f32_bf16 v138, v61, v114, v122
    v_dot2_f32_bf16 v139, v61, v115, v123
    v_dot2_f32_bf16 v140, v62, v116, v124
    v_dot2_f32_bf16 v141, v62, v117, v125
    v_dot2_f32_bf16 v142, v63, v118, v126
    v_dot2_f32_bf16 v143, v63, v119, v127
    v_cvt_pk_bf16_f32 v56, v128, v129
    v_cvt_pk_bf16_f32 v57, v130, v131
    v_cvt_pk_bf16_f32 v58, v132, v133
    v_cvt_pk_bf16_f32 v59, v134, v135
    v_cvt_pk_bf16_f32 v60, v136, v137
    v_cvt_pk_bf16_f32 v61, v138, v139
    v_cvt_pk_bf16_f32 v62, v140, v141
    v_cvt_pk_bf16_f32 v63, v142, v143
    s_waitcnt lgkmcnt(0)
    s_barrier
    v_mfma_f32_16x16x32_bf16 v[16:19], v[72:75], v[56:59], v[16:19]
    ds_read_b128 v[64:67], v11
    ds_read_b128 v[68:71], v11 offset:2048
    v_mfma_f32_16x16x32_bf16 v[36:39], v[72:75], v[60:63], v[36:39]
    ds_read_b128 v[112:115], v9 offset:256
    ds_read_b128 v[116:119], v9 offset:272
    v_mfma_f32_16x16x32_bf16 v[20:23], v[76:79], v[56:59], v[20:23]
    ds_read_b128 v[120:123], v9 offset:2816
    ds_read_b128 v[124:127], v9 offset:2832
    v_mfma_f32_16x16x32_bf16 v[40:43], v[76:79], v[60:63], v[40:43]
    ds_read_b128 v[92:95], v12 offset:0
    ds_read_b128 v[96:99], v12 offset:2048
    v_mfma_f32_16x16x32_bf16 v[24:27], v[80:83], v[56:59], v[24:27]
    ds_read_b128 v[100:103], v12 offset:4096
    ds_read_b128 v[104:107], v12 offset:6144
    v_mfma_f32_16x16x32_bf16 v[44:47], v[80:83], v[60:63], v[44:47]
    ds_read_b128 v[108:111], v12 offset:8192
    v_add_u32 v12, s57, v13
    v_mfma_f32_16x16x32_bf16 v[28:31], v[84:87], v[56:59], v[28:31]
    v_add_u32 v11, s56, v10
    s_add_u32 s56, s56, 8192
    v_mfma_f32_16x16x32_bf16 v[48:51], v[84:87], v[60:63], v[48:51]
    s_cmp_ge_u32 s56, 88064
    s_cselect_b32 s56, 47104, s56
    v_mfma_f32_16x16x32_bf16 v[32:35], v[88:91], v[56:59], v[32:35]
    s_add_u32 s57, s57, 10240
    s_cmp_ge_u32 s57, 149504
    v_mfma_f32_16x16x32_bf16 v[52:55], v[88:91], v[60:63], v[52:55]
    s_cselect_b32 s57, 88064, s57
    s_waitcnt lgkmcnt(5)
    v_dot2_f32_bf16 v128, v64, v112, v120
    v_dot2_f32_bf16 v129, v64, v113, v121
    v_dot2_f32_bf16 v130, v65, v114, v122
    v_dot2_f32_bf16 v131, v65, v115, v123
    v_dot2_f32_bf16 v132, v66, v116, v124
    v_dot2_f32_bf16 v133, v66, v117, v125
    v_dot2_f32_bf16 v134, v67, v118, v126
    v_dot2_f32_bf16 v135, v67, v119, v127
    v_dot2_f32_bf16 v136, v68, v112, v120
    v_dot2_f32_bf16 v137, v68, v113, v121
    v_dot2_f32_bf16 v138, v69, v114, v122
    v_dot2_f32_bf16 v139, v69, v115, v123
    v_dot2_f32_bf16 v140, v70, v116, v124
    v_dot2_f32_bf16 v141, v70, v117, v125
    v_dot2_f32_bf16 v142, v71, v118, v126
    v_dot2_f32_bf16 v143, v71, v119, v127
    v_cvt_pk_bf16_f32 v64, v128, v129
    v_cvt_pk_bf16_f32 v65, v130, v131
    v_cvt_pk_bf16_f32 v66, v132, v133
    v_cvt_pk_bf16_f32 v67, v134, v135
    v_cvt_pk_bf16_f32 v68, v136, v137
    v_cvt_pk_bf16_f32 v69, v138, v139
    v_cvt_pk_bf16_f32 v70, v140, v141
    v_cvt_pk_bf16_f32 v71, v142, v143
    s_waitcnt lgkmcnt(0)
    s_barrier
    v_mfma_f32_16x16x32_bf16 v[16:19], v[92:95], v[64:67], v[16:19]
    ds_read_b128 v[56:59], v11
    ds_read_b128 v[60:63], v11 offset:2048
    v_mfma_f32_16x16x32_bf16 v[36:39], v[92:95], v[68:71], v[36:39]
    ds_read_b128 v[112:115], v9 offset:512
    ds_read_b128 v[116:119], v9 offset:528
    v_mfma_f32_16x16x32_bf16 v[20:23], v[96:99], v[64:67], v[20:23]
    ds_read_b128 v[120:123], v9 offset:3072
    ds_read_b128 v[124:127], v9 offset:3088
    v_mfma_f32_16x16x32_bf16 v[40:43], v[96:99], v[68:71], v[40:43]
    ds_read_b128 v[72:75], v12 offset:0
    ds_read_b128 v[76:79], v12 offset:2048
    v_mfma_f32_16x16x32_bf16 v[24:27], v[100:103], v[64:67], v[24:27]
    ds_read_b128 v[80:83], v12 offset:4096
    ds_read_b128 v[84:87], v12 offset:6144
    v_mfma_f32_16x16x32_bf16 v[44:47], v[100:103], v[68:71], v[44:47]
    ds_read_b128 v[88:91], v12 offset:8192
    v_add_u32 v12, s57, v13
    v_mfma_f32_16x16x32_bf16 v[28:31], v[104:107], v[64:67], v[28:31]
    v_add_u32 v11, s56, v10
    s_add_u32 s56, s56, 8192
    v_mfma_f32_16x16x32_bf16 v[48:51], v[104:107], v[68:71], v[48:51]
    s_cmp_ge_u32 s56, 88064
    s_cselect_b32 s56, 47104, s56
    v_mfma_f32_16x16x32_bf16 v[32:35], v[108:111], v[64:67], v[32:35]
    s_add_u32 s57, s57, 10240
    s_cmp_ge_u32 s57, 149504
    v_mfma_f32_16x16x32_bf16 v[52:55], v[108:111], v[68:71], v[52:55]
    s_cselect_b32 s57, 88064, s57
    s_waitcnt lgkmcnt(5)
    v_dot2_f32_bf16 v128, v56, v112, v120
    v_dot2_f32_bf16 v129, v56, v113, v121
    v_dot2_f32_bf16 v130, v57, v114, v122
    v_dot2_f32_bf16 v131, v57, v115, v123
    v_dot2_f32_bf16 v132, v58, v116, v124
    v_dot2_f32_bf16 v133, v58, v117, v125
    v_dot2_f32_bf16 v134, v59, v118, v126
    v_dot2_f32_bf16 v135, v59, v119, v127
    v_dot2_f32_bf16 v136, v60, v112, v120
    v_dot2_f32_bf16 v137, v60, v113, v121
    v_dot2_f32_bf16 v138, v61, v114, v122
    v_dot2_f32_bf16 v139, v61, v115, v123
    v_dot2_f32_bf16 v140, v62, v116, v124
    v_dot2_f32_bf16 v141, v62, v117, v125
    v_dot2_f32_bf16 v142, v63, v118, v126
    v_dot2_f32_bf16 v143, v63, v119, v127
    v_cvt_pk_bf16_f32 v56, v128, v129
    v_cvt_pk_bf16_f32 v57, v130, v131
    v_cvt_pk_bf16_f32 v58, v132, v133
    v_cvt_pk_bf16_f32 v59, v134, v135
    v_cvt_pk_bf16_f32 v60, v136, v137
    v_cvt_pk_bf16_f32 v61, v138, v139
    v_cvt_pk_bf16_f32 v62, v140, v141
    v_cvt_pk_bf16_f32 v63, v142, v143
    s_waitcnt lgkmcnt(0)
    s_barrier
    v_mfma_f32_16x16x32_bf16 v[16:19], v[72:75], v[56:59], v[16:19]
    ds_read_b128 v[64:67], v11
    ds_read_b128 v[68:71], v11 offset:2048
    v_mfma_f32_16x16x32_bf16 v[36:39], v[72:75], v[60:63], v[36:39]
    ds_read_b128 v[112:115], v9 offset:768
    ds_read_b128 v[116:119], v9 offset:784
    v_mfma_f32_16x16x32_bf16 v[20:23], v[76:79], v[56:59], v[20:23]
    ds_read_b128 v[120:123], v9 offset:3328
    ds_read_b128 v[124:127], v9 offset:3344
    v_mfma_f32_16x16x32_bf16 v[40:43], v[76:79], v[60:63], v[40:43]
    ds_read_b128 v[92:95], v12 offset:0
    ds_read_b128 v[96:99], v12 offset:2048
    v_mfma_f32_16x16x32_bf16 v[24:27], v[80:83], v[56:59], v[24:27]
    ds_read_b128 v[100:103], v12 offset:4096
    ds_read_b128 v[104:107], v12 offset:6144
    v_mfma_f32_16x16x32_bf16 v[44:47], v[80:83], v[60:63], v[44:47]
    ds_read_b128 v[108:111], v12 offset:8192
    v_add_u32 v12, s57, v13
    v_mfma_f32_16x16x32_bf16 v[28:31], v[84:87], v[56:59], v[28:31]
    v_add_u32 v11, s56, v10
    s_add_u32 s56, s56, 8192
    v_mfma_f32_16x16x32_bf16 v[48:51], v[84:87], v[60:63], v[48:51]
    s_cmp_ge_u32 s56, 88064
    s_cselect_b32 s56, 47104, s56
    v_mfma_f32_16x16x32_bf16 v[32:35], v[88:91], v[56:59], v[32:35]
    s_add_u32 s57, s57, 10240
    s_cmp_ge_u32 s57, 149504
    v_mfma_f32_16x16x32_bf16 v[52:55], v[88:91], v[60:63], v[52:55]
    s_cselect_b32 s57, 88064, s57
    s_waitcnt lgkmcnt(5)
    v_dot2_f32_bf16 v128, v64, v112, v120
    v_dot2_f32_bf16 v129, v64, v113, v121
    v_dot2_f32_bf16 v130, v65, v114, v122
    v_dot2_f32_bf16 v131, v65, v115, v123
    v_dot2_f32_bf16 v132, v66, v116, v124
    v_dot2_f32_bf16 v133, v66, v117, v125
    v_dot2_f32_bf16 v134, v67, v118, v126
    v_dot2_f32_bf16 v135, v67, v119, v127
    v_dot2_f32_bf16 v136, v68, v112, v120
    v_dot2_f32_bf16 v137, v68, v113, v121
    v_dot2_f32_bf16 v138, v69, v114, v122
    v_dot2_f32_bf16 v139, v69, v115, v123
    v_dot2_f32_bf16 v140, v70, v116, v124
    v_dot2_f32_bf16 v141, v70, v117, v125
    v_dot2_f32_bf16 v142, v71, v118, v126
    v_dot2_f32_bf16 v143, v71, v119, v127
    v_cvt_pk_bf16_f32 v64, v128, v129
    v_cvt_pk_bf16_f32 v65, v130, v131
    v_cvt_pk_bf16_f32 v66, v132, v133
    v_cvt_pk_bf16_f32 v67, v134, v135
    v_cvt_pk_bf16_f32 v68, v136, v137
    v_cvt_pk_bf16_f32 v69, v138, v139
    v_cvt_pk_bf16_f32 v70, v140, v141
    v_cvt_pk_bf16_f32 v71, v142, v143
    s_waitcnt lgkmcnt(0)
    s_barrier
    v_mfma_f32_16x16x32_bf16 v[16:19], v[92:95], v[64:67], v[16:19]
    ds_read_b128 v[56:59], v11
    ds_read_b128 v[60:63], v11 offset:2048
    v_mfma_f32_16x16x32_bf16 v[36:39], v[92:95], v[68:71], v[36:39]
    ds_read_b128 v[112:115], v9 offset:1024
    ds_read_b128 v[116:119], v9 offset:1040
    v_mfma_f32_16x16x32_bf16 v[20:23], v[96:99], v[64:67], v[20:23]
    ds_read_b128 v[120:123], v9 offset:3584
    ds_read_b128 v[124:127], v9 offset:3600
    v_mfma_f32_16x16x32_bf16 v[40:43], v[96:99], v[68:71], v[40:43]
    ds_read_b128 v[72:75], v12 offset:0
    ds_read_b128 v[76:79], v12 offset:2048
    v_mfma_f32_16x16x32_bf16 v[24:27], v[100:103], v[64:67], v[24:27]
    ds_read_b128 v[80:83], v12 offset:4096
    ds_read_b128 v[84:87], v12 offset:6144
    v_mfma_f32_16x16x32_bf16 v[44:47], v[100:103], v[68:71], v[44:47]
    ds_read_b128 v[88:91], v12 offset:8192
    v_add_u32 v12, s57, v13
    v_mfma_f32_16x16x32_bf16 v[28:31], v[104:107], v[64:67], v[28:31]
    v_add_u32 v11, s56, v10
    s_add_u32 s56, s56, 8192
    v_mfma_f32_16x16x32_bf16 v[48:51], v[104:107], v[68:71], v[48:51]
    s_cmp_ge_u32 s56, 88064
    s_cselect_b32 s56, 47104, s56
    v_mfma_f32_16x16x32_bf16 v[32:35], v[108:111], v[64:67], v[32:35]
    s_add_u32 s57, s57, 10240
    s_cmp_ge_u32 s57, 149504
    v_mfma_f32_16x16x32_bf16 v[52:55], v[108:111], v[68:71], v[52:55]
    s_cselect_b32 s57, 88064, s57
    s_waitcnt lgkmcnt(5)
    v_dot2_f32_bf16 v128, v56, v112, v120
    v_dot2_f32_bf16 v129, v56, v113, v121
    v_dot2_f32_bf16 v130, v57, v114, v122
    v_dot2_f32_bf16 v131, v57, v115, v123
    v_dot2_f32_bf16 v132, v58, v116, v124
    v_dot2_f32_bf16 v133, v58, v117, v125
    v_dot2_f32_bf16 v134, v59, v118, v126
    v_dot2_f32_bf16 v135, v59, v119, v127
    v_dot2_f32_bf16 v136, v60, v112, v120
    v_dot2_f32_bf16 v137, v60, v113, v121
    v_dot2_f32_bf16 v138, v61, v114, v122
    v_dot2_f32_bf16 v139, v61, v115, v123
    v_dot2_f32_bf16 v140, v62, v116, v124
    v_dot2_f32_bf16 v141, v62, v117, v125
    v_dot2_f32_bf16 v142, v63, v118, v126
    v_dot2_f32_bf16 v143, v63, v119, v127
    v_cvt_pk_bf16_f32 v56, v128, v129
    v_cvt_pk_bf16_f32 v57, v130, v131
    v_cvt_pk_bf16_f32 v58, v132, v133
    v_cvt_pk_bf16_f32 v59, v134, v135
    v_cvt_pk_bf16_f32 v60, v136, v137
    v_cvt_pk_bf16_f32 v61, v138, v139
    v_cvt_pk_bf16_f32 v62, v140, v141
    v_cvt_pk_bf16_f32 v63, v142, v143
    s_cmp_lg_u32 s3, 3
    s_cbranch_scc1 Q_PUB_1
    s_lshl_b32 s30, s2, 7
    s_add_u32 s30, s30, 917504
    v_mov_b32 v14, 1
    v_mov_b32 v15, 0
    s_waitcnt vmcnt(0)
    s_mov_b64 exec, 1
    buffer_store_dword v14, v15, s[12:15], s30 offen sc1
    s_mov_b64 exec, -1
Q_PUB_1:
    s_nop 0
    s_waitcnt lgkmcnt(0)
    s_barrier
    v_mfma_f32_16x16x32_bf16 v[16:19], v[72:75], v[56:59], v[16:19]
    ds_read_b128 v[64:67], v11
    ds_read_b128 v[68:71], v11 offset:2048
    v_mfma_f32_16x16x32_bf16 v[36:39], v[72:75], v[60:63], v[36:39]
    ds_read_b128 v[112:115], v9 offset:1280
    ds_read_b128 v[116:119], v9 offset:1296
    v_mfma_f32_16x16x32_bf16 v[20:23], v[76:79], v[56:59], v[20:23]
    ds_read_b128 v[120:123], v9 offset:3840
    ds_read_b128 v[124:127], v9 offset:3856
    v_mfma_f32_16x16x32_bf16 v[40:43], v[76:79], v[60:63], v[40:43]
    ds_read_b128 v[92:95], v12 offset:0
    ds_read_b128 v[96:99], v12 offset:2048
    v_mfma_f32_16x16x32_bf16 v[24:27], v[80:83], v[56:59], v[24:27]
    ds_read_b128 v[100:103], v12 offset:4096
    ds_read_b128 v[104:107], v12 offset:6144
    v_mfma_f32_16x16x32_bf16 v[44:47], v[80:83], v[60:63], v[44:47]
    ds_read_b128 v[108:111], v12 offset:8192
    v_add_u32 v12, s57, v13
    v_mfma_f32_16x16x32_bf16 v[28:31], v[84:87], v[56:59], v[28:31]
    v_add_u32 v11, s56, v10
    s_add_u32 s56, s56, 8192
    v_mfma_f32_16x16x32_bf16 v[48:51], v[84:87], v[60:63], v[48:51]
    s_cmp_ge_u32 s56, 88064
    s_cselect_b32 s56, 47104, s56
    v_mfma_f32_16x16x32_bf16 v[32:35], v[88:91], v[56:59], v[32:35]
    s_add_u32 s57, s57, 10240
    s_cmp_ge_u32 s57, 149504
    v_mfma_f32_16x16x32_bf16 v[52:55], v[88:91], v[60:63], v[52:55]
    s_cselect_b32 s57, 88064, s57
    s_waitcnt lgkmcnt(5)
    v_dot2_f32_bf16 v128, v64, v112, v120
    v_dot2_f32_bf16 v129, v64, v113, v121
    v_dot2_f32_bf16 v130, v65, v114, v122
    v_dot2_f32_bf16 v131, v65, v115, v123
    v_dot2_f32_bf16 v132, v66, v116, v124
    v_dot2_f32_bf16 v133, v66, v117, v125
    v_dot2_f32_bf16 v134, v67, v118, v126
    v_dot2_f32_bf16 v135, v67, v119, v127
    v_dot2_f32_bf16 v136, v68, v112, v120
    v_dot2_f32_bf16 v137, v68, v113, v121
    v_dot2_f32_bf16 v138, v69, v114, v122
    v_dot2_f32_bf16 v139, v69, v115, v123
    v_dot2_f32_bf16 v140, v70, v116, v124
    v_dot2_f32_bf16 v141, v70, v117, v125
    v_dot2_f32_bf16 v142, v71, v118, v126
    v_dot2_f32_bf16 v143, v71, v119, v127
    v_cvt_pk_bf16_f32 v64, v128, v129
    v_cvt_pk_bf16_f32 v65, v130, v131
    v_cvt_pk_bf16_f32 v66, v132, v133
    v_cvt_pk_bf16_f32 v67, v134, v135
    v_cvt_pk_bf16_f32 v68, v136, v137
    v_cvt_pk_bf16_f32 v69, v138, v139
    v_cvt_pk_bf16_f32 v70, v140, v141
    v_cvt_pk_bf16_f32 v71, v142, v143
    s_waitcnt lgkmcnt(0)
    s_barrier
    v_mfma_f32_16x16x32_bf16 v[16:19], v[92:95], v[64:67], v[16:19]
    ds_read_b128 v[56:59], v11
    ds_read_b128 v[60:63], v11 offset:2048
    v_mfma_f32_16x16x32_bf16 v[36:39], v[92:95], v[68:71], v[36:39]
    ds_read_b128 v[112:115], v9 offset:1536
    ds_read_b128 v[116:119], v9 offset:1552
    v_mfma_f32_16x16x32_bf16 v[20:23], v[96:99], v[64:67], v[20:23]
    ds_read_b128 v[120:123], v9 offset:4096
    ds_read_b128 v[124:127], v9 offset:4112
    v_mfma_f32_16x16x32_bf16 v[40:43], v[96:99], v[68:71], v[40:43]
    ds_read_b128 v[72:75], v12 offset:0
    ds_read_b128 v[76:79], v12 offset:2048
    v_mfma_f32_16x16x32_bf16 v[24:27], v[100:103], v[64:67], v[24:27]
    ds_read_b128 v[80:83], v12 offset:4096
    ds_read_b128 v[84:87], v12 offset:6144
    v_mfma_f32_16x16x32_bf16 v[44:47], v[100:103], v[68:71], v[44:47]
    ds_read_b128 v[88:91], v12 offset:8192
    v_add_u32 v12, s57, v13
    v_mfma_f32_16x16x32_bf16 v[28:31], v[104:107], v[64:67], v[28:31]
    v_add_u32 v11, s56, v10
    s_add_u32 s56, s56, 8192
    v_mfma_f32_16x16x32_bf16 v[48:51], v[104:107], v[68:71], v[48:51]
    s_cmp_ge_u32 s56, 88064
    s_cselect_b32 s56, 47104, s56
    v_mfma_f32_16x16x32_bf16 v[32:35], v[108:111], v[64:67], v[32:35]
    s_add_u32 s57, s57, 10240
    s_cmp_ge_u32 s57, 149504
    v_mfma_f32_16x16x32_bf16 v[52:55], v[108:111], v[68:71], v[52:55]
    s_cselect_b32 s57, 88064, s57
    s_waitcnt lgkmcnt(5)
    v_dot2_f32_bf16 v128, v56, v112, v120
    v_dot2_f32_bf16 v129, v56, v113, v121
    v_dot2_f32_bf16 v130, v57, v114, v122
    v_dot2_f32_bf16 v131, v57, v115, v123
    v_dot2_f32_bf16 v132, v58, v116, v124
    v_dot2_f32_bf16 v133, v58, v117, v125
    v_dot2_f32_bf16 v134, v59, v118, v126
    v_dot2_f32_bf16 v135, v59, v119, v127
    v_dot2_f32_bf16 v136, v60, v112, v120
    v_dot2_f32_bf16 v137, v60, v113, v121
    v_dot2_f32_bf16 v138, v61, v114, v122
    v_dot2_f32_bf16 v139, v61, v115, v123
    v_dot2_f32_bf16 v140, v62, v116, v124
    v_dot2_f32_bf16 v141, v62, v117, v125
    v_dot2_f32_bf16 v142, v63, v118, v126
    v_dot2_f32_bf16 v143, v63, v119, v127
    v_cvt_pk_bf16_f32 v56, v128, v129
    v_cvt_pk_bf16_f32 v57, v130, v131
    v_cvt_pk_bf16_f32 v58, v132, v133
    v_cvt_pk_bf16_f32 v59, v134, v135
    v_cvt_pk_bf16_f32 v60, v136, v137
    v_cvt_pk_bf16_f32 v61, v138, v139
    v_cvt_pk_bf16_f32 v62, v140, v141
    v_cvt_pk_bf16_f32 v63, v142, v143
    s_waitcnt lgkmcnt(0)
    s_barrier
    v_mfma_f32_16x16x32_bf16 v[16:19], v[72:75], v[56:59], v[16:19]
    ds_read_b128 v[64:67], v11
    ds_read_b128 v[68:71], v11 offset:2048
    v_mfma_f32_16x16x32_bf16 v[36:39], v[72:75], v[60:63], v[36:39]
    ds_read_b128 v[112:115], v9 offset:1792
    ds_read_b128 v[116:119], v9 offset:1808
    v_mfma_f32_16x16x32_bf16 v[20:23], v[76:79], v[56:59], v[20:23]
    ds_read_b128 v[120:123], v9 offset:4352
    ds_read_b128 v[124:127], v9 offset:4368
    v_mfma_f32_16x16x32_bf16 v[40:43], v[76:79], v[60:63], v[40:43]
    ds_read_b128 v[92:95], v12 offset:0
    ds_read_b128 v[96:99], v12 offset:2048
    v_mfma_f32_16x16x32_bf16 v[24:27], v[80:83], v[56:59], v[24:27]
    ds_read_b128 v[100:103], v12 offset:4096
    ds_read_b128 v[104:107], v12 offset:6144
    v_mfma_f32_16x16x32_bf16 v[44:47], v[80:83], v[60:63], v[44:47]
    ds_read_b128 v[108:111], v12 offset:8192
    v_add_u32 v12, s57, v13
    v_mfma_f32_16x16x32_bf16 v[28:31], v[84:87], v[56:59], v[28:31]
    v_add_u32 v11, s56, v10
    s_add_u32 s56, s56, 8192
    v_mfma_f32_16x16x32_bf16 v[48:51], v[84:87], v[60:63], v[48:51]
    s_cmp_ge_u32 s56, 88064
    s_cselect_b32 s56, 47104, s56
    v_mfma_f32_16x16x32_bf16 v[32:35], v[88:91], v[56:59], v[32:35]
    s_add_u32 s57, s57, 10240
    s_cmp_ge_u32 s57, 149504
    v_mfma_f32_16x16x32_bf16 v[52:55], v[88:91], v[60:63], v[52:55]
    s_cselect_b32 s57, 88064, s57
    s_waitcnt lgkmcnt(5)
    v_dot2_f32_bf16 v128, v64, v112, v120
    v_dot2_f32_bf16 v129, v64, v113, v121
    v_dot2_f32_bf16 v130, v65, v114, v122
    v_dot2_f32_bf16 v131, v65, v115, v123
    v_dot2_f32_bf16 v132, v66, v116, v124
    v_dot2_f32_bf16 v133, v66, v117, v125
    v_dot2_f32_bf16 v134, v67, v118, v126
    v_dot2_f32_bf16 v135, v67, v119, v127
    v_dot2_f32_bf16 v136, v68, v112, v120
    v_dot2_f32_bf16 v137, v68, v113, v121
    v_dot2_f32_bf16 v138, v69, v114, v122
    v_dot2_f32_bf16 v139, v69, v115, v123
    v_dot2_f32_bf16 v140, v70, v116, v124
    v_dot2_f32_bf16 v141, v70, v117, v125
    v_dot2_f32_bf16 v142, v71, v118, v126
    v_dot2_f32_bf16 v143, v71, v119, v127
    v_cvt_pk_bf16_f32 v64, v128, v129
    v_cvt_pk_bf16_f32 v65, v130, v131
    v_cvt_pk_bf16_f32 v66, v132, v133
    v_cvt_pk_bf16_f32 v67, v134, v135
    v_cvt_pk_bf16_f32 v68, v136, v137
    v_cvt_pk_bf16_f32 v69, v138, v139
    v_cvt_pk_bf16_f32 v70, v140, v141
    v_cvt_pk_bf16_f32 v71, v142, v143
    s_waitcnt lgkmcnt(0)
    s_barrier
    v_mfma_f32_16x16x32_bf16 v[16:19], v[92:95], v[64:67], v[16:19]
    ds_read_b128 v[56:59], v11
    ds_read_b128 v[60:63], v11 offset:2048
    v_mfma_f32_16x16x32_bf16 v[36:39], v[92:95], v[68:71], v[36:39]
    ds_read_b128 v[112:115], v9 offset:2048
    ds_read_b128 v[116:119], v9 offset:2064
    v_mfma_f32_16x16x32_bf16 v[20:23], v[96:99], v[64:67], v[20:23]
    ds_read_b128 v[120:123], v9 offset:4608
    ds_read_b128 v[124:127], v9 offset:4624
    v_mfma_f32_16x16x32_bf16 v[40:43], v[96:99], v[68:71], v[40:43]
    ds_read_b128 v[72:75], v12 offset:0
    ds_read_b128 v[76:79], v12 offset:2048
    v_mfma_f32_16x16x32_bf16 v[24:27], v[100:103], v[64:67], v[24:27]
    ds_read_b128 v[80:83], v12 offset:4096
    ds_read_b128 v[84:87], v12 offset:6144
    v_mfma_f32_16x16x32_bf16 v[44:47], v[100:103], v[68:71], v[44:47]
    ds_read_b128 v[88:91], v12 offset:8192
    v_add_u32 v12, s57, v13
    v_mfma_f32_16x16x32_bf16 v[28:31], v[104:107], v[64:67], v[28:31]
    v_add_u32 v11, s56, v10
    s_add_u32 s56, s56, 8192
    v_mfma_f32_16x16x32_bf16 v[48:51], v[104:107], v[68:71], v[48:51]
    s_cmp_ge_u32 s56, 88064
    s_cselect_b32 s56, 47104, s56
    v_mfma_f32_16x16x32_bf16 v[32:35], v[108:111], v[64:67], v[32:35]
    s_add_u32 s57, s57, 10240
    s_cmp_ge_u32 s57, 149504
    v_mfma_f32_16x16x32_bf16 v[52:55], v[108:111], v[68:71], v[52:55]
    s_cselect_b32 s57, 88064, s57
    s_waitcnt lgkmcnt(5)
    v_dot2_f32_bf16 v128, v56, v112, v120
    v_dot2_f32_bf16 v129, v56, v113, v121
    v_dot2_f32_bf16 v130, v57, v114, v122
    v_dot2_f32_bf16 v131, v57, v115, v123
    v_dot2_f32_bf16 v132, v58, v116, v124
    v_dot2_f32_bf16 v133, v58, v117, v125
    v_dot2_f32_bf16 v134, v59, v118, v126
    v_dot2_f32_bf16 v135, v59, v119, v127
    v_dot2_f32_bf16 v136, v60, v112, v120
    v_dot2_f32_bf16 v137, v60, v113, v121
    v_dot2_f32_bf16 v138, v61, v114, v122
    v_dot2_f32_bf16 v139, v61, v115, v123
    v_dot2_f32_bf16 v140, v62, v116, v124
    v_dot2_f32_bf16 v141, v62, v117, v125
    v_dot2_f32_bf16 v142, v63, v118, v126
    v_dot2_f32_bf16 v143, v63, v119, v127
    v_cvt_pk_bf16_f32 v56, v128, v129
    v_cvt_pk_bf16_f32 v57, v130, v131
    v_cvt_pk_bf16_f32 v58, v132, v133
    v_cvt_pk_bf16_f32 v59, v134, v135
    v_cvt_pk_bf16_f32 v60, v136, v137
    v_cvt_pk_bf16_f32 v61, v138, v139
    v_cvt_pk_bf16_f32 v62, v140, v141
    v_cvt_pk_bf16_f32 v63, v142, v143
    s_waitcnt lgkmcnt(0)
    s_barrier
    v_mfma_f32_16x16x32_bf16 v[16:19], v[72:75], v[56:59], v[16:19]
    ds_read_b128 v[64:67], v11
    ds_read_b128 v[68:71], v11 offset:2048
    v_mfma_f32_16x16x32_bf16 v[36:39], v[72:75], v[60:63], v[36:39]
    ds_read_b128 v[112:115], v9 offset:2304
    ds_read_b128 v[116:119], v9 offset:2320
    v_mfma_f32_16x16x32_bf16 v[20:23], v[76:79], v[56:59], v[20:23]
    ds_read_b128 v[120:123], v9 offset:4864
    ds_read_b128 v[124:127], v9 offset:4880
    v_mfma_f32_16x16x32_bf16 v[40:43], v[76:79], v[60:63], v[40:43]
    ds_read_b128 v[92:95], v12 offset:0
    ds_read_b128 v[96:99], v12 offset:2048
    v_mfma_f32_16x16x32_bf16 v[24:27], v[80:83], v[56:59], v[24:27]
    ds_read_b128 v[100:103], v12 offset:4096
    ds_read_b128 v[104:107], v12 offset:6144
    v_mfma_f32_16x16x32_bf16 v[44:47], v[80:83], v[60:63], v[44:47]
    ds_read_b128 v[108:111], v12 offset:8192
    v_add_u32 v12, s57, v13
    v_mfma_f32_16x16x32_bf16 v[28:31], v[84:87], v[56:59], v[28:31]
    v_add_u32 v11, s56, v10
    s_add_u32 s56, s56, 8192
    v_mfma_f32_16x16x32_bf16 v[48:51], v[84:87], v[60:63], v[48:51]
    s_cmp_ge_u32 s56, 88064
    s_cselect_b32 s56, 47104, s56
    v_mfma_f32_16x16x32_bf16 v[32:35], v[88:91], v[56:59], v[32:35]
    s_add_u32 s57, s57, 10240
    s_cmp_ge_u32 s57, 149504
    v_mfma_f32_16x16x32_bf16 v[52:55], v[88:91], v[60:63], v[52:55]
    s_cselect_b32 s57, 88064, s57
    s_waitcnt lgkmcnt(5)
    v_dot2_f32_bf16 v128, v64, v112, v120
    v_dot2_f32_bf16 v129, v64, v113, v121
    v_dot2_f32_bf16 v130, v65, v114, v122
    v_dot2_f32_bf16 v131, v65, v115, v123
    v_dot2_f32_bf16 v132, v66, v116, v124
    v_dot2_f32_bf16 v133, v66, v117, v125
    v_dot2_f32_bf16 v134, v67, v118, v126
    v_dot2_f32_bf16 v135, v67, v119, v127
    v_dot2_f32_bf16 v136, v68, v112, v120
    v_dot2_f32_bf16 v137, v68, v113, v121
    v_dot2_f32_bf16 v138, v69, v114, v122
    v_dot2_f32_bf16 v139, v69, v115, v123
    v_dot2_f32_bf16 v140, v70, v116, v124
    v_dot2_f32_bf16 v141, v70, v117, v125
    v_dot2_f32_bf16 v142, v71, v118, v126
    v_dot2_f32_bf16 v143, v71, v119, v127
    v_cvt_pk_bf16_f32 v64, v128, v129
    v_cvt_pk_bf16_f32 v65, v130, v131
    v_cvt_pk_bf16_f32 v66, v132, v133
    v_cvt_pk_bf16_f32 v67, v134, v135
    v_cvt_pk_bf16_f32 v68, v136, v137
    v_cvt_pk_bf16_f32 v69, v138, v139
    v_cvt_pk_bf16_f32 v70, v140, v141
    v_cvt_pk_bf16_f32 v71, v142, v143
    s_waitcnt lgkmcnt(0)
    s_barrier
    v_mfma_f32_16x16x32_bf16 v[16:19], v[92:95], v[64:67], v[16:19]
    v_mfma_f32_16x16x32_bf16 v[36:39], v[92:95], v[68:71], v[36:39]
    v_mfma_f32_16x16x32_bf16 v[20:23], v[96:99], v[64:67], v[20:23]
    v_mfma_f32_16x16x32_bf16 v[40:43], v[96:99], v[68:71], v[40:43]
    v_mfma_f32_16x16x32_bf16 v[24:27], v[100:103], v[64:67], v[24:27]
    v_mfma_f32_16x16x32_bf16 v[44:47], v[100:103], v[68:71], v[44:47]
    v_mfma_f32_16x16x32_bf16 v[28:31], v[104:107], v[64:67], v[28:31]
    v_mfma_f32_16x16x32_bf16 v[48:51], v[104:107], v[68:71], v[48:51]
    v_mfma_f32_16x16x32_bf16 v[32:35], v[108:111], v[64:67], v[32:35]
    v_mfma_f32_16x16x32_bf16 v[52:55], v[108:111], v[68:71], v[52:55]
    s_mul_i32 s26, s3, 5120
    s_add_u32 s26, s26, 122880
    v_add_u32 v14, s26, v2
    s_xor_b32 s28, s3, 1
    s_mul_i32 s28, s28, 5120
    s_add_u32 s28, s28, 122880
    v_add_u32 v15, s28, v2
    s_cmp_eq_u32 s27, 1
    s_cbranch_scc1 QX_2
    ds_write_b128 v15, v[36:39] offset:0
    ds_write_b128 v15, v[40:43] offset:1024
    ds_write_b128 v15, v[44:47] offset:2048
    ds_write_b128 v15, v[48:51] offset:3072
    ds_write_b128 v15, v[52:55] offset:4096
    s_branch QX_3
QX_2:
    ds_write_b128 v15, v[16:19] offset:0
    ds_write_b128 v15, v[20:23] offset:1024
    ds_write_b128 v15, v[24:27] offset:2048
    ds_write_b128 v15, v[28:31] offset:3072
    ds_write_b128 v15, v[32:35] offset:4096
    v_pk_add_f32 v[16:17], v[36:37], 0
    v_pk_add_f32 v[18:19], v[38:39], 0
    v_pk_add_f32 v[20:21], v[40:41], 0
    v_pk_add_f32 v[22:23], v[42:43], 0
    v_pk_add_f32 v[24:25], v[44:45], 0
    v_pk_add_f32 v[26:27], v[46:47], 0
    v_pk_add_f32 v[28:29], v[48:49], 0
    v_pk_add_f32 v[30:31], v[50:51], 0
    v_pk_add_f32 v[32:33], v[52:53], 0
    v_pk_add_f32 v[34:35], v[54:55], 0
QX_3:
    s_waitcnt lgkmcnt(0)
    s_barrier
    ds_read_b128 v[36:39], v14 offset:0
    ds_read_b128 v[40:43], v14 offset:1024
    ds_read_b128 v[44:47], v14 offset:2048
    ds_read_b128 v[48:51], v14 offset:3072
    ds_read_b128 v[52:55], v14 offset:4096
    v_and_b32 v9, 15, v1
    v_mul_u32_u24 v9, 160, v9
    v_lshl_add_u32 v9, v6, 3, v9
    s_mul_i32 s26, s3, 2560
    s_add_u32 s26, s26, 104704
    v_add_u32 v9, s26, v9
    v_mov_b32 v10, 0x3ea52b5c
    v_mov_b32 v11, 0x3ea52b5c
    s_waitcnt lgkmcnt(0)
    v_pk_add_f32 v[16:17], v[16:17], v[36:37]
    v_pk_add_f32 v[18:19], v[18:19], v[38:39]
    v_pk_add_f32 v[20:21], v[20:21], v[40:41]
    v_pk_add_f32 v[22:23], v[22:23], v[42:43]
    v_pk_add_f32 v[24:25], v[24:25], v[44:45]
    v_pk_add_f32 v[26:27], v[26:27], v[46:47]
    v_pk_add_f32 v[28:29], v[28:29], v[48:49]
    v_pk_add_f32 v[30:31], v[30:31], v[50:51]
    v_pk_add_f32 v[32:33], v[32:33], v[52:53]
    v_pk_add_f32 v[34:35], v[34:35], v[54:55]
    v_pk_mul_f32 v[16:17], v[16:17], v[10:11]
    v_pk_mul_f32 v[18:19], v[18:19], v[10:11]
    v_pk_mul_f32 v[20:21], v[20:21], v[10:11]
    v_pk_mul_f32 v[22:23], v[22:23], v[10:11]
    v_pk_mul_f32 v[24:25], v[24:25], v[10:11]
    v_pk_mul_f32 v[26:27], v[26:27], v[10:11]
    v_pk_mul_f32 v[28:29], v[28:29], v[10:11]
    v_pk_mul_f32 v[30:31], v[30:31], v[10:11]
    v_pk_mul_f32 v[32:33], v[32:33], v[10:11]
    v_pk_mul_f32 v[34:35], v[34:35], v[10:11]
    v_cvt_pk_bf16_f32 v36, v16, v17
    v_cvt_pk_bf16_f32 v37, v18, v19
    v_cvt_pk_bf16_f32 v38, v20, v21
    v_cvt_pk_bf16_f32 v39, v22, v23
    v_cvt_pk_bf16_f32 v40, v24, v25
    v_cvt_pk_bf16_f32 v41, v26, v27
    v_cvt_pk_bf16_f32 v42, v28, v29
    v_cvt_pk_bf16_f32 v43, v30, v31
    v_cvt_pk_bf16_f32 v44, v32, v33
    v_cvt_pk_bf16_f32 v45, v34, v35
    ds_write_b64 v9, v[36:37] offset:0
    ds_write_b64 v9, v[38:39] offset:32
    ds_write_b64 v9, v[40:41] offset:64
    ds_write_b64 v9, v[42:43] offset:96
    ds_write_b64 v9, v[44:45] offset:128
    s_branch Q_DONE
Q_LOADER:
    s_and_b32 s26, s3, 1
    s_mul_i32 s45, s20, 81920
    s_add_u32 s45, s45, 9437184
    s_mul_i32 s46, s21, 102400
    s_add_u32 s46, s46, 1048576
    s_waitcnt lgkmcnt(0)
    s_mov_b32 s12, s4
    s_and_b32 s13, s5, 0xffff
    s_mov_b32 s14, 268435456
    s_mov_b32 s15, 0x00020000
    s_cmp_ge_u32 s3, 6
    s_cbranch_scc1 Q_BLOADER
    s_mul_i32 s60, s26, 1024
    s_add_u32 s72, s60, 0
    s_add_u32 s60, s60, 0
    s_add_u32 s60, s60, s45
    s_mul_i32 s61, s26, 1024
    s_add_u32 s73, s61, 2048
    s_add_u32 s61, s61, 20480
    s_add_u32 s61, s61, s45
    s_mul_i32 s62, s26, 1024
    s_add_u32 s74, s62, 4096
    s_add_u32 s62, s62, 40960
    s_add_u32 s62, s62, s45
    s_mul_i32 s63, s26, 1024
    s_add_u32 s75, s63, 6144
    s_add_u32 s63, s63, 61440
    s_add_u32 s63, s63, s45
    s_mov_b32 s56, 47104
    s_mov_b32 s57, 3
LQA_E:
    s_add_u32 m0, s72, s56
    s_nop 0
    buffer_load_dwordx4 v2, s[12:15], s60 offen  lds
    s_add_u32 s60, s60, 2048
    s_add_u32 m0, s73, s56
    s_nop 0
    buffer_load_dwordx4 v2, s[12:15], s61 offen  lds
    s_add_u32 s61, s61, 2048
    s_add_u32 m0, s74, s56
    s_nop 0
    buffer_load_dwordx4 v2, s[12:15], s62 offen  lds
    s_add_u32 s62, s62, 2048
    s_add_u32 m0, s75, s56
    s_nop 0
    buffer_load_dwordx4 v2, s[12:15], s63 offen  lds
    s_add_u32 s63, s63, 2048
    s_add_u32 s56, s56, 8192
    s_cmp_ge_u32 s56, 88064
    s_cselect_b32 s56, 47104, s56
    s_sub_u32 s57, s57, 1
    s_cmp_lg_u32 s57, 0
    s_cbranch_scc1 LQA_E
    s_barrier
    s_barrier
    s_add_u32 m0, s72, s56
    s_nop 0
    buffer_load_dwordx4 v2, s[12:15], s60 offen  lds
    s_add_u32 s60, s60, 2048
    s_add_u32 m0, s73, s56
    s_nop 0
    buffer_load_dwordx4 v2, s[12:15], s61 offen  lds
    s_add_u32 s61, s61, 2048
    s_add_u32 m0, s74, s56
    s_nop 0
    buffer_load_dwordx4 v2, s[12:15], s62 offen  lds
    s_add_u32 s62, s62, 2048
    s_add_u32 m0, s75, s56
    s_nop 0
    buffer_load_dwordx4 v2, s[12:15], s63 offen  lds
    s_add_u32 s63, s63, 2048
    s_add_u32 s56, s56, 8192
    s_cmp_ge_u32 s56, 88064
    s_cselect_b32 s56, 47104, s56
    s_mov_b32 s57, 2
LQA_L:
    s_waitcnt vmcnt(12)
    s_barrier
    s_add_u32 m0, s72, s56
    s_nop 0
    buffer_load_dwordx4 v2, s[12:15], s60 offen  lds
    s_add_u32 s60, s60, 2048
    s_add_u32 m0, s73, s56
    s_nop 0
    buffer_load_dwordx4 v2, s[12:15], s61 offen  lds
    s_add_u32 s61, s61, 2048
    s_add_u32 m0, s74, s56
    s_nop 0
    buffer_load_dwordx4 v2, s[12:15], s62 offen  lds
    s_add_u32 s62, s62, 2048
    s_add_u32 m0, s75, s56
    s_nop 0
    buffer_load_dwordx4 v2, s[12:15], s63 offen  lds
    s_add_u32 s63, s63, 2048
    s_add_u32 s56, s56, 8192
    s_cmp_ge_u32 s56, 88064
    s_cselect_b32 s56, 47104, s56
    s_waitcnt vmcnt(12)
    s_barrier
    s_add_u32 m0, s72, s56
    s_nop 0
    buffer_load_dwordx4 v2, s[12:15], s60 offen  lds
    s_add_u32 s60, s60, 2048
    s_add_u32 m0, s73, s56
    s_nop 0
    buffer_load_dwordx4 v2, s[12:15], s61 offen  lds
    s_add_u32 s61, s61, 2048
    s_add_u32 m0, s74, s56
    s_nop 0
    buffer_load_dwordx4 v2, s[12:15], s62 offen  lds
    s_add_u32 s62, s62, 2048
    s_add_u32 m0, s75, s56
    s_nop 0
    buffer_load_dwordx4 v2, s[12:15], s63 offen  lds
    s_add_u32 s63, s63, 2048
    s_add_u32 s56, s56, 8192
    s_cmp_ge_u32 s56, 88064
    s_cselect_b32 s56, 47104, s56
    s_waitcnt vmcnt(12)
    s_barrier
    s_add_u32 m0, s72, s56
    s_nop 0
    buffer_load_dwordx4 v2, s[12:15], s60 offen  lds
    s_add_u32 s60, s60, 2048
    s_add_u32 m0, s73, s56
    s_nop 0
    buffer_load_dwordx4 v2, s[12:15], s61 offen  lds
    s_add_u32 s61, s61, 2048
    s_add_u32 m0, s74, s56
    s_nop 0
    buffer_load_dwordx4 v2, s[12:15], s62 offen  lds
    s_add_u32 s62, s62, 2048
    s_add_u32 m0, s75, s56
    s_nop 0
    buffer_load_dwordx4 v2, s[12:15], s63 offen  lds
    s_add_u32 s63, s63, 2048
    s_add_u32 s56, s56, 8192
    s_cmp_ge_u32 s56, 88064
    s_cselect_b32 s56, 47104, s56
    s_sub_u32 s57, s57, 1
    s_cmp_lg_u32 s57, 0
    s_cbranch_scc1 LQA_L
    s_waitcnt vmcnt(12)
    s_barrier
    s_waitcnt vmcnt(8)
    s_barrier
    s_waitcnt vmcnt(4)
    s_barrier
    s_waitcnt vmcnt(0)
    s_barrier
    s_barrier
    s_cmp_lg_u32 s3, 4
    s_cbranch_scc1 Q_LX
    v_lshlrev_b32 v4, 7, v1
    s_mov_b32 s33, 0
Q_FKV:
    s_mov_b32 s25, 917504
    buffer_load_dword v5, v4, s[12:15], s25 offen sc1
    s_mov_b32 s25, 925696
    buffer_load_dword v6, v4, s[12:15], s25 offen sc1
    s_mov_b32 s25, 933888
    buffer_load_dword v7, v4, s[12:15], s25 offen sc1
    s_mov_b32 s25, 942080
    buffer_load_dword v8, v4, s[12:15], s25 offen sc1
    s_add_u32 s33, s33, 1
    s_waitcnt vmcnt(0)
    v_min_u32 v5, v5, v6
    v_min_u32 v7, v7, v8
    v_min_u32 v5, v5, v7
    v_cmp_eq_u32 s[36:37], 0, v5
    s_cmp_gt_u32 s33, 200000
    s_cselect_b64 s[36:37], 0, s[36:37]
    s_cmp_lg_u64 s[36:37], 0
    s_cbranch_scc1 Q_FKV
    s_branch Q_LX
Q_BLOADER:
    s_mul_i32 s60, s26, 1024
    s_add_u32 s72, s60, 0
    s_add_u32 s60, s60, 0
    s_add_u32 s60, s60, s46
    s_mul_i32 s61, s26, 1024
    s_add_u32 s73, s61, 2048
    s_add_u32 s61, s61, 20480
    s_add_u32 s61, s61, s46
    s_mul_i32 s62, s26, 1024
    s_add_u32 s74, s62, 4096
    s_add_u32 s62, s62, 40960
    s_add_u32 s62, s62, s46
    s_mul_i32 s63, s26, 1024
    s_add_u32 s75, s63, 6144
    s_add_u32 s63, s63, 61440
    s_add_u32 s63, s63, s46
    s_mul_i32 s64, s26, 1024
    s_add_u32 s76, s64, 8192
    s_add_u32 s64, s64, 81920
    s_add_u32 s64, s64, s46
    s_mov_b32 s56, 88064
    s_mov_b32 s57, 3
LQB_E:
    s_add_u32 m0, s72, s56
    s_nop 0
    buffer_load_dwordx4 v2, s[12:15], s60 offen  lds
    s_add_u32 s60, s60, 2048
    s_add_u32 m0, s73, s56
    s_nop 0
    buffer_load_dwordx4 v2, s[12:15], s61 offen  lds
    s_add_u32 s61, s61, 2048
    s_add_u32 m0, s74, s56
    s_nop 0
    buffer_load_dwordx4 v2, s[12:15], s62 offen  lds
    s_add_u32 s62, s62, 2048
    s_add_u32 m0, s75, s56
    s_nop 0
    buffer_load_dwordx4 v2, s[12:15], s63 offen  lds
    s_add_u32 s63, s63, 2048
    s_add_u32 m0, s76, s56
    s_nop 0
    buffer_load_dwordx4 v2, s[12:15], s64 offen  lds
    s_add_u32 s64, s64, 2048
    s_add_u32 s56, s56, 10240
    s_cmp_ge_u32 s56, 149504
    s_cselect_b32 s56, 88064, s56
    s_sub_u32 s57, s57, 1
    s_cmp_lg_u32 s57, 0
    s_cbranch_scc1 LQB_E
    s_barrier
    s_barrier
    s_add_u32 m0, s72, s56
    s_nop 0
    buffer_load_dwordx4 v2, s[12:15], s60 offen  lds
    s_add_u32 s60, s60, 2048
    s_add_u32 m0, s73, s56
    s_nop 0
    buffer_load_dwordx4 v2, s[12:15], s61 offen  lds
    s_add_u32 s61, s61, 2048
    s_add_u32 m0, s74, s56
    s_nop 0
    buffer_load_dwordx4 v2, s[12:15], s62 offen  lds
    s_add_u32 s62, s62, 2048
    s_add_u32 m0, s75, s56
    s_nop 0
    buffer_load_dwordx4 v2, s[12:15], s63 offen  lds
    s_add_u32 s63, s63, 2048
    s_add_u32 m0, s76, s56
    s_nop 0
    buffer_load_dwordx4 v2, s[12:15], s64 offen  lds
    s_add_u32 s64, s64, 2048
    s_add_u32 s56, s56, 10240
    s_cmp_ge_u32 s56, 149504
    s_cselect_b32 s56, 88064, s56
    s_mov_b32 s57, 2
LQB_L:
    s_waitcnt vmcnt(15)
    s_barrier
    s_add_u32 m0, s72, s56
    s_nop 0
    buffer_load_dwordx4 v2, s[12:15], s60 offen  lds
    s_add_u32 s60, s60, 2048
    s_add_u32 m0, s73, s56
    s_nop 0
    buffer_load_dwordx4 v2, s[12:15], s61 offen  lds
    s_add_u32 s61, s61, 2048
    s_add_u32 m0, s74, s56
    s_nop 0
    buffer_load_dwordx4 v2, s[12:15], s62 offen  lds
    s_add_u32 s62, s62, 2048
    s_add_u32 m0, s75, s56
    s_nop 0
    buffer_load_dwordx4 v2, s[12:15], s63 offen  lds
    s_add_u32 s63, s63, 2048
    s_add_u32 m0, s76, s56
    s_nop 0
    buffer_load_dwordx4 v2, s[12:15], s64 offen  lds
    s_add_u32 s64, s64, 2048
    s_add_u32 s56, s56, 10240
    s_cmp_ge_u32 s56, 149504
    s_cselect_b32 s56, 88064, s56
    s_waitcnt vmcnt(15)
    s_barrier
    s_add_u32 m0, s72, s56
    s_nop 0
    buffer_load_dwordx4 v2, s[12:15], s60 offen  lds
    s_add_u32 s60, s60, 2048
    s_add_u32 m0, s73, s56
    s_nop 0
    buffer_load_dwordx4 v2, s[12:15], s61 offen  lds
    s_add_u32 s61, s61, 2048
    s_add_u32 m0, s74, s56
    s_nop 0
    buffer_load_dwordx4 v2, s[12:15], s62 offen  lds
    s_add_u32 s62, s62, 2048
    s_add_u32 m0, s75, s56
    s_nop 0
    buffer_load_dwordx4 v2, s[12:15], s63 offen  lds
    s_add_u32 s63, s63, 2048
    s_add_u32 m0, s76, s56
    s_nop 0
    buffer_load_dwordx4 v2, s[12:15], s64 offen  lds
    s_add_u32 s64, s64, 2048
    s_add_u32 s56, s56, 10240
    s_cmp_ge_u32 s56, 149504
    s_cselect_b32 s56, 88064, s56
    s_waitcnt vmcnt(15)
    s_barrier
    s_add_u32 m0, s72, s56
    s_nop 0
    buffer_load_dwordx4 v2, s[12:15], s60 offen  lds
    s_add_u32 s60, s60, 2048
    s_add_u32 m0, s73, s56
    s_nop 0
    buffer_load_dwordx4 v2, s[12:15], s61 offen  lds
    s_add_u32 s61, s61, 2048
    s_add_u32 m0, s74, s56
    s_nop 0
    buffer_load_dwordx4 v2, s[12:15], s62 offen  lds
    s_add_u32 s62, s62, 2048
    s_add_u32 m0, s75, s56
    s_nop 0
    buffer_load_dwordx4 v2, s[12:15], s63 offen  lds
    s_add_u32 s63, s63, 2048
    s_add_u32 m0, s76, s56
    s_nop 0
    buffer_load_dwordx4 v2, s[12:15], s64 offen  lds
    s_add_u32 s64, s64, 2048
    s_add_u32 s56, s56, 10240
    s_cmp_ge_u32 s56, 149504
    s_cselect_b32 s56, 88064, s56
    s_sub_u32 s57, s57, 1
    s_cmp_lg_u32 s57, 0
    s_cbranch_scc1 LQB_L
    s_waitcnt vmcnt(15)
    s_barrier
    s_waitcnt vmcnt(10)
    s_barrier
    s_waitcnt vmcnt(5)
    s_barrier
    s_waitcnt vmcnt(0)
    s_barrier
    s_barrier
Q_LX:
    s_nop 0
    s_barrier
Q_DONE:
    v_lshrrev_b32 v126, 5, v1
    v_and_b32 v127, 31, v1
    v_lshlrev_b32 v6, 3, v1
    v_mul_u32_u24 v124, 1280, v127
    v_lshl_add_u32 v128, v126, 4, v124
    v_mov_b32 v129, 0x40000000
    v_cmp_eq_u32 vcc, 0, v126
    s_nop 1
    v_cndmask_b32 v129, v129, v124, vcc
    s_lshl_b32 s22, s20, 1
    s_and_b32 s23, s3, 1
    s_add_u32 s22, s22, s23
    s_mul_i32 s22, s22, 40960
    s_lshl_b32 s23, s21, 2
    s_lshr_b32 s24, s3, 1
    s_add_u32 s23, s23, s24
    s_mul_i32 s23, s23, 40
    s_add_u32 s22, s22, s23
    s_add_u32 s22, s22, 12582912
    v_mul_u32_u24 v7, 21, v126
    v_add_u32 v7, v7, v127
    v_lshlrev_b32 v7, 4, v7
    v_add_u32 v7, 12288, v7
    v_cmp_gt_u32 s[38:39], 21, v127
    v_lshlrev_b32 v130, 2, v1
    s_add_u32 s24, s3, 0
    s_min_u32 s24, s24, 22
    s_lshl_b32 s46, s24, 10
    s_add_u32 s25, s46, 131072
    s_add_u32 s26, s46, 217088
    s_cmp_lt_u32 s24, 12
    s_cselect_b32 s40, s25, s26
    s_mov_b32 s43, 10752
    s_cselect_b32 s43, 12288, s43
    s_add_u32 s24, s3, 8
    s_min_u32 s24, s24, 22
    s_lshl_b32 s47, s24, 10
    s_add_u32 s25, s47, 131072
    s_add_u32 s26, s47, 217088
    s_cmp_lt_u32 s24, 12
    s_cselect_b32 s41, s25, s26
    s_mov_b32 s44, 10752
    s_cselect_b32 s44, 12288, s44
    s_add_u32 s24, s3, 16
    s_min_u32 s24, s24, 22
    s_lshl_b32 s48, s24, 10
    s_add_u32 s25, s48, 131072
    s_add_u32 s26, s48, 217088
    s_cmp_lt_u32 s24, 12
    s_cselect_b32 s42, s25, s26
    s_mov_b32 s45, 10752
    s_cselect_b32 s45, 12288, s45
    s_add_u32 m0, s46, 0
    s_nop 0
    buffer_load_dwordx4 v2, s[12:15], s40 offen sc1 lds
    s_add_u32 s40, s40, s43
    s_add_u32 m0, s47, 0
    s_nop 0
    buffer_load_dwordx4 v2, s[12:15], s41 offen sc1 lds
    s_add_u32 s41, s41, s44
    s_add_u32 m0, s48, 0
    s_nop 0
    buffer_load_dwordx4 v2, s[12:15], s42 offen sc1 lds
    s_add_u32 s42, s42, s45
    s_mov_b32 s24, 81920
    buffer_load_dword v100, v130, s[12:15], s24 offen sc1
    buffer_load_dword v101, v130, s[12:15], s24 offen offset:256 sc1
    buffer_load_dword v102, v130, s[12:15], s24 offen offset:512 sc1
    buffer_load_dword v103, v130, s[12:15], s24 offen offset:768 sc1
    v_mul_u32_u24 v128, 160, v127
    s_and_b32 s24, s3, 1
    s_mul_i32 s24, s24, 5120
    s_lshr_b32 s25, s3, 1
    s_mul_i32 s25, s25, 40
    s_add_u32 s24, s24, s25
    s_add_u32 s24, s24, 104704
    v_add_u32 v128, s24, v128
    v_lshl_add_u32 v129, v126, 4, v128
    v_mov_b32 v96, 0
    v_mov_b32 v97, 0
    s_waitcnt lgkmcnt(0)
    s_barrier
    ds_read_b64 v[92:93], v129
    ds_read_b64 v[94:95], v129 offset:8
    s_mov_b32 exec_hi, 0
    ds_read_b64 v[96:97], v128 offset:32
    s_mov_b64 exec, -1
    s_cmp_lg_u32 s3, 7
    s_cbranch_scc1 A_NOXID
    s_lshl_b32 s24, s2, 7
    s_add_u32 s24, s24, 753664
    v_mov_b32 v104, s90
    v_mov_b32 v105, 0
    s_mov_b64 exec, 1
    buffer_store_dword v104, v105, s[12:15], s24 offen sc1
    s_mov_b64 exec, -1
A_NOXID:
    v_mov_b32 v28, 0
    v_mov_b32 v76, 0
    v_mov_b32 v29, 0
    v_mov_b32 v77, 0
    v_mov_b32 v30, 0
    v_mov_b32 v78, 0
    v_mov_b32 v31, 0
    v_mov_b32 v79, 0
    v_mov_b32 v32, 0
    v_mov_b32 v80, 0
    v_mov_b32 v33, 0
    v_mov_b32 v81, 0
    v_mov_b32 v34, 0
    v_mov_b32 v82, 0
    v_mov_b32 v35, 0
    v_mov_b32 v83, 0
    v_mov_b32 v36, 0
    v_mov_b32 v84, 0
    v_mov_b32 v37, 0
    v_mov_b32 v85, 0
    v_mov_b32 v38, 0
    v_mov_b32 v86, 0
    v_mov_b32 v39, 0
    v_mov_b32 v87, 0
    v_mov_b32 v40, 0
    v_mov_b32 v88, 0
    v_mov_b32 v41, 0
    v_mov_b32 v89, 0
    v_mov_b32 v42, 0
    v_mov_b32 v90, 0
    v_mov_b32 v43, 0
    v_mov_b32 v91, 0
    v_mov_b32 v64, 0
    v_mov_b32 v65, 0
    v_mov_b32 v66, 0
    v_mov_b32 v67, 0
    s_lshl_b32 s56, s3, 8
    s_add_u32 s56, s56, s2
    s_cmp_lt_u32 s56, 1080
    s_cselect_b32 s57, 1, 99
    s_add_u32 s58, s57, 1
    s_cmp_eq_u32 s3, 0
    s_cselect_b32 s70, 4, 99
    s_cmp_eq_u32 s3, 7
    s_cselect_b32 s70, 6, s70
    s_mov_b32 s77, 0
    s_lshl_b32 s49, s3, 8
    s_add_u32 s49, s49, s2
    s_sub_u32 s49, s49, 1280
    s_cmp_lt_u32 s49, 10
    s_cselect_b32 s49, 1, 99
    s_and_b32 s50, s3, 1
    s_add_u32 s50, s50, 99
    s_add_u32 s51, s3, 4
    s_and_b32 s51, s51, 7
    s_lshr_b32 s51, s51, 1
    s_add_u32 s51, s51, 2
    s_cmp_lt_u32 s3, 4
    s_cselect_b32 s76, 6, 99
    v_mov_b32 v3, v2
    v_add_u32 v4, 1024, v6
    v_mov_b32 v5, v7
    s_waitcnt vmcnt(0) lgkmcnt(0)
    v_dot2_f32_bf16 v131, v92, v92, 0
    v_dot2_f32_bf16 v131, v93, v93, v131
    v_dot2_f32_bf16 v131, v94, v94, v131
    v_dot2_f32_bf16 v131, v95, v95, v131
    v_dot2_f32_bf16 v131, v96, v96, v131
    v_dot2_f32_bf16 v131, v97, v97, v131
    v_max_f32 v100, v100, v101
    v_max_f32 v102, v102, v103
    v_mov_b32 v133, 0x47800000
    v_mov_b32 v132, v131
    v_cmp_nle_f32 s[26:27], v102, v133
    s_nop 0
    v_permlane32_swap_b32 v131, v132
    v_add_f32 v131, v131, v132
    s_nop 1
    v_max_f32_dpp v131, v131, v131 row_ror:8 row_mask:0xf bank_mask:0xf
    s_nop 1
    v_max_f32_dpp v131, v131, v131 row_ror:4 row_mask:0xf bank_mask:0xf
    s_nop 1
    v_max_f32_dpp v131, v131, v131 row_ror:2 row_mask:0xf bank_mask:0xf
    s_nop 1
    v_max_f32_dpp v131, v131, v131 row_ror:1 row_mask:0xf bank_mask:0xf
    v_mov_b32 v132, v131
    v_mov_b32 v133, 0x46100000
    s_nop 0
    v_permlane16_swap_b32 v131, v132
    v_max_f32 v131, v131, v132
    v_mul_f32 v100, v100, v131
    v_cmp_nle_f32 vcc, v100, v133
    s_or_b64 vcc, vcc, s[26:27]
    s_cmp_lg_u64 vcc, 0
    s_cselect_b32 s24, 1, 0
    v_mov_b32 v132, s24
    s_lshl_b32 s24, s3, 2
    v_mov_b32 v133, s24
    v_add_u32 v133, 94208, v133
    ds_write_b32 v133, v132
    v_and_b32 v131, 7, v1
    v_lshlrev_b32 v131, 2, v131
    v_add_u32 v131, 94208, v131
    v_add_u32 v8, 64, v133
    v_add_u32 v9, 64, v131
    v_mov_b32 v134, 0
    ds_write_b32 v8, v134
    s_mov_b32 s35, 0
    s_waitcnt lgkmcnt(0)
    s_barrier
    ds_read_b32 v132, v131
    ds_read_b128 v[16:19], v3
    ds_read_b64 v[24:25], v4
    ds_read_b128 v[20:23], v3 offset:1536
    ds_read_b64 v[26:27], v4 offset:1536
    s_waitcnt lgkmcnt(4)
    v_cmp_ne_u32 vcc, 0, v132
    s_cmp_lg_u64 vcc, 0
    s_cbranch_scc1 A_SLOW
A_RESUME:
    s_mov_b32 s30, 0
    s_mov_b32 s31, 23552
    s_mov_b32 s32, 70656
    s_waitcnt lgkmcnt(0)
    v_mfma_f32_32x32x16_bf16 v[44:59], v[16:19], v[92:95], 0
    v_mfma_f32_32x32x8_bf16 v[44:59], v[24:25], v[96:97], v[44:59]
    s_add_u32 m0, s46, 23552
    s_nop 0
    buffer_load_dwordx4 v2, s[12:15], s40 offen sc1 lds
    s_add_u32 s40, s40, s43
    s_add_u32 m0, s47, 23552
    s_nop 0
    buffer_load_dwordx4 v2, s[12:15], s41 offen sc1 lds
    s_add_u32 s41, s41, s44
    s_add_u32 m0, s48, 23552
    s_nop 0
    buffer_load_dwordx4 v2, s[12:15], s42 offen sc1 lds
    s_add_u32 s42, s42, s45
    s_add_u32 m0, s46, 47104
    s_nop 0
    buffer_load_dwordx4 v2, s[12:15], s40 offen sc1 lds
    s_add_u32 s40, s40, s43
    s_add_u32 m0, s47, 47104
    s_nop 0
    buffer_load_dwordx4 v2, s[12:15], s41 offen sc1 lds
    s_add_u32 s41, s41, s44
    s_add_u32 m0, s48, 47104
    s_nop 0
    buffer_load_dwordx4 v2, s[12:15], s42 offen sc1 lds
    s_add_u32 s42, s42, s45
    s_add_u32 s59, s57, 2
A_LOOP:
    s_setprio 1
    v_exp_f32 v44, v44
    v_exp_f32 v45, v45
    v_mfma_f32_32x32x16_bf16 v[76:91], v[40:43], v[64:67], v[76:91]
    v_exp_f32 v46, v46
    s_mov_b64 exec, s[38:39]
    ds_read_b128 v[28:31], v5 offset:0
    ds_read_b128 v[32:35], v5 offset:672
    s_mov_b64 exec, -1
    v_exp_f32 v47, v47
    v_exp_f32 v48, v48
    v_exp_f32 v49, v49
    s_waitcnt lgkmcnt(2)
    v_mfma_f32_32x32x16_bf16 v[60:75], v[20:23], v[92:95], 0
    v_exp_f32 v50, v50
    ds_read_b128 v[16:19], v3 offset:3072
    ds_read_b64 v[24:25], v4 offset:3072
    v_exp_f32 v51, v51
    v_cvt_pk_bf16_f32 v44, v44, v45
    v_cvt_pk_bf16_f32 v45, v46, v47
    v_cvt_pk_bf16_f32 v46, v48, v49
    v_mfma_f32_32x32x8_bf16 v[60:75], v[26:27], v[96:97], v[60:75]
    v_cvt_pk_bf16_f32 v47, v50, v51
    v_exp_f32 v52, v52
    v_exp_f32 v53, v53
    v_exp_f32 v54, v54
    v_exp_f32 v55, v55
    s_waitcnt lgkmcnt(2)
    v_mfma_f32_32x32x16_bf16 v[76:91], v[28:31], v[44:47], v[76:91]
    v_exp_f32 v56, v56
    v_exp_f32 v57, v57
    v_cvt_pk_bf16_f32 v48, v52, v53
    v_cvt_pk_bf16_f32 v49, v54, v55
    v_exp_f32 v58, v58
    v_exp_f32 v59, v59
    v_cvt_pk_bf16_f32 v50, v56, v57
    v_cvt_pk_bf16_f32 v51, v58, v59
    s_setprio 0
    v_exp_f32 v60, v60
    v_exp_f32 v61, v61
    v_mfma_f32_32x32x16_bf16 v[76:91], v[32:35], v[48:51], v[76:91]
    v_exp_f32 v62, v62
    s_mov_b64 exec, s[38:39]
    ds_read_b128 v[36:39], v5 offset:1344
    ds_read_b128 v[40:43], v5 offset:2016
    s_mov_b64 exec, -1
    v_exp_f32 v63, v63
    v_exp_f32 v64, v64
    v_exp_f32 v65, v65
    s_waitcnt lgkmcnt(2)
    v_mfma_f32_32x32x16_bf16 v[44:59], v[16:19], v[92:95], 0
    v_exp_f32 v66, v66
    ds_read_b128 v[20:23], v3 offset:4608
    ds_read_b64 v[26:27], v4 offset:4608
    v_exp_f32 v67, v67
    v_cvt_pk_bf16_f32 v60, v60, v61
    v_cvt_pk_bf16_f32 v61, v62, v63
    v_cvt_pk_bf16_f32 v62, v64, v65
    v_mfma_f32_32x32x8_bf16 v[44:59], v[24:25], v[96:97], v[44:59]
    v_cvt_pk_bf16_f32 v63, v66, v67
    v_exp_f32 v68, v68
    v_exp_f32 v69, v69
    v_exp_f32 v70, v70
    v_exp_f32 v71, v71
    s_waitcnt lgkmcnt(2)
    v_mfma_f32_32x32x16_bf16 v[76:91], v[36:39], v[60:63], v[76:91]
    v_exp_f32 v72, v72
    v_exp_f32 v73, v73
    s_waitcnt vmcnt(3)
    s_add_u32 s34, s30, 1
    v_mov_b32 v132, s34
    ds_write_b32 v8, v132
    v_cvt_pk_bf16_f32 v64, v68, v69
    v_cvt_pk_bf16_f32 v65, v70, v71
    v_exp_f32 v74, v74
    v_exp_f32 v75, v75
    v_cvt_pk_bf16_f32 v66, v72, v73
    v_cvt_pk_bf16_f32 v67, v74, v75
    s_setprio 3
    v_exp_f32 v44, v44
    v_exp_f32 v45, v45
    v_mfma_f32_32x32x16_bf16 v[76:91], v[40:43], v[64:67], v[76:91]
    v_exp_f32 v46, v46
    s_mov_b64 exec, s[38:39]
    ds_read_b128 v[28:31], v5 offset:2688
    ds_read_b128 v[32:35], v5 offset:3360
    s_mov_b64 exec, -1
    v_exp_f32 v47, v47
    v_exp_f32 v48, v48
    s_cmp_eq_u32 s30, s50
    s_cbranch_scc1 A_JOBH
A_JOBH_RET:
    v_exp_f32 v49, v49
    s_waitcnt lgkmcnt(2)
    v_mfma_f32_32x32x16_bf16 v[60:75], v[20:23], v[92:95], 0
    v_exp_f32 v50, v50
    ds_read_b128 v[16:19], v3 offset:6144
    ds_read_b64 v[24:25], v4 offset:6144
    v_exp_f32 v51, v51
    v_cvt_pk_bf16_f32 v44, v44, v45
    v_cvt_pk_bf16_f32 v45, v46, v47
    s_cmp_eq_u32 s30, s59
    s_cbranch_scc1 A_JOBD
A_JOBD_RET:
    v_cvt_pk_bf16_f32 v46, v48, v49
    v_mfma_f32_32x32x8_bf16 v[60:75], v[26:27], v[96:97], v[60:75]
    v_cvt_pk_bf16_f32 v47, v50, v51
    v_exp_f32 v52, v52
    v_exp_f32 v53, v53
    v_exp_f32 v54, v54
    v_exp_f32 v55, v55
    s_waitcnt lgkmcnt(2)
    v_mfma_f32_32x32x16_bf16 v[76:91], v[28:31], v[44:47], v[76:91]
    v_exp_f32 v56, v56
    v_exp_f32 v57, v57
    v_cvt_pk_bf16_f32 v48, v52, v53
    v_cvt_pk_bf16_f32 v49, v54, v55
    s_cmp_eq_u32 s30, s51
    s_cbranch_scc1 A_JOBF
A_JOBF_RET:
    v_exp_f32 v58, v58
    v_exp_f32 v59, v59
    v_cvt_pk_bf16_f32 v50, v56, v57
    v_cvt_pk_bf16_f32 v51, v58, v59
    s_setprio 2
    v_exp_f32 v60, v60
    v_exp_f32 v61, v61
    v_mfma_f32_32x32x16_bf16 v[76:91], v[32:35], v[48:51], v[76:91]
    v_exp_f32 v62, v62
    s_mov_b64 exec, s[38:39]
    ds_read_b128 v[36:39], v5 offset:4032
    ds_read_b128 v[40:43], v5 offset:4704
    s_mov_b64 exec, -1
    v_exp_f32 v63, v63
    v_exp_f32 v64, v64
    v_exp_f32 v65, v65
    s_waitcnt lgkmcnt(2)
    v_mfma_f32_32x32x16_bf16 v[44:59], v[16:19], v[92:95], 0
    v_exp_f32 v66, v66
    ds_read_b128 v[20:23], v3 offset:7680
    ds_read_b64 v[26:27], v4 offset:7680
    v_exp_f32 v67, v67
    v_cvt_pk_bf16_f32 v60, v60, v61
    v_cvt_pk_bf16_f32 v61, v62, v63
    s_cmp_eq_u32 s30, s57
    s_cbranch_scc1 A_JOBA
A_JOBA_RET:
    v_cvt_pk_bf16_f32 v62, v64, v65
    v_mfma_f32_32x32x8_bf16 v[44:59], v[24:25], v[96:97], v[44:59]
    v_cvt_pk_bf16_f32 v63, v66, v67
    v_exp_f32 v68, v68
    v_exp_f32 v69, v69
    v_exp_f32 v70, v70
    v_exp_f32 v71, v71
    s_waitcnt lgkmcnt(2)
    v_mfma_f32_32x32x16_bf16 v[76:91], v[36:39], v[60:63], v[76:91]
    v_exp_f32 v72, v72
    v_exp_f32 v73, v73
    v_cvt_pk_bf16_f32 v64, v68, v69
    v_cvt_pk_bf16_f32 v65, v70, v71
    s_cmp_ge_u32 s30, 3
    s_cbranch_scc1 A_JOBG
A_JOBG_RET:
    v_exp_f32 v74, v74
    v_exp_f32 v75, v75
    v_cvt_pk_bf16_f32 v66, v72, v73
    v_cvt_pk_bf16_f32 v67, v74, v75
    s_setprio 1
    v_exp_f32 v44, v44
    v_exp_f32 v45, v45
    v_mfma_f32_32x32x16_bf16 v[76:91], v[40:43], v[64:67], v[76:91]
    v_exp_f32 v46, v46
    s_mov_b64 exec, s[38:39]
    ds_read_b128 v[28:31], v5 offset:5376
    ds_read_b128 v[32:35], v5 offset:6048
    s_mov_b64 exec, -1
    v_exp_f32 v47, v47
    v_exp_f32 v48, v48
    v_exp_f32 v49, v49
    s_waitcnt lgkmcnt(2)
    v_mfma_f32_32x32x16_bf16 v[60:75], v[20:23], v[92:95], 0
    v_exp_f32 v50, v50
    ds_read_b128 v[16:19], v3 offset:9216
    ds_read_b64 v[24:25], v4 offset:9216
    v_exp_f32 v51, v51
    v_cvt_pk_bf16_f32 v44, v44, v45
    v_cvt_pk_bf16_f32 v45, v46, v47
    s_cmp_eq_u32 s30, s76
    s_cbranch_scc1 A_JOBE
A_JOBE_RET:
    v_cvt_pk_bf16_f32 v46, v48, v49
    v_mfma_f32_32x32x8_bf16 v[60:75], v[26:27], v[96:97], v[60:75]
    v_cvt_pk_bf16_f32 v47, v50, v51
    v_exp_f32 v52, v52
    v_exp_f32 v53, v53
    v_exp_f32 v54, v54
    v_exp_f32 v55, v55
    s_waitcnt lgkmcnt(2)
    v_mfma_f32_32x32x16_bf16 v[76:91], v[28:31], v[44:47], v[76:91]
    v_exp_f32 v56, v56
    v_exp_f32 v57, v57
    v_cvt_pk_bf16_f32 v48, v52, v53
    v_cvt_pk_bf16_f32 v49, v54, v55
    v_exp_f32 v58, v58
    v_exp_f32 v59, v59
    v_cvt_pk_bf16_f32 v50, v56, v57
    v_cvt_pk_bf16_f32 v51, v58, v59
    s_setprio 0
    v_exp_f32 v60, v60
    v_exp_f32 v61, v61
    v_mfma_f32_32x32x16_bf16 v[76:91], v[32:35], v[48:51], v[76:91]
    v_exp_f32 v62, v62
    s_mov_b64 exec, s[38:39]
    ds_read_b128 v[36:39], v5 offset:6720
    ds_read_b128 v[40:43], v5 offset:7392
    s_mov_b64 exec, -1
    v_exp_f32 v63, v63
    v_exp_f32 v64, v64
    v_exp_f32 v65, v65
    s_waitcnt lgkmcnt(2)
    v_mfma_f32_32x32x16_bf16 v[44:59], v[16:19], v[92:95], 0
    v_exp_f32 v66, v66
    ds_read_b128 v[20:23], v3 offset:10752
    ds_read_b64 v[26:27], v4 offset:10752
    v_exp_f32 v67, v67
    v_cvt_pk_bf16_f32 v60, v60, v61
    v_cvt_pk_bf16_f32 v61, v62, v63
    s_cmp_eq_u32 s30, s49
    s_cbranch_scc1 A_JOBM
A_JOBM_RET:
    v_cvt_pk_bf16_f32 v62, v64, v65
    v_mfma_f32_32x32x8_bf16 v[44:59], v[24:25], v[96:97], v[44:59]
    v_cvt_pk_bf16_f32 v63, v66, v67
    v_exp_f32 v68, v68
    v_exp_f32 v69, v69
    v_exp_f32 v70, v70
    v_exp_f32 v71, v71
    s_waitcnt lgkmcnt(2)
    v_mfma_f32_32x32x16_bf16 v[76:91], v[36:39], v[60:63], v[76:91]
    v_exp_f32 v72, v72
    v_exp_f32 v73, v73
    v_cvt_pk_bf16_f32 v64, v68, v69
    v_cvt_pk_bf16_f32 v65, v70, v71
    v_exp_f32 v74, v74
    v_exp_f32 v75, v75
    v_cvt_pk_bf16_f32 v66, v72, v73
    v_cvt_pk_bf16_f32 v67, v74, v75
    s_setprio 3
A_KVC_4:
    ds_read_b32 v133, v9
    s_add_u32 s35, s35, 1
    s_waitcnt lgkmcnt(0)
    v_cmp_gt_u32 vcc, s34, v133
    s_cmp_gt_u32 s35, 1000000
    s_cselect_b64 s[36:37], 0, vcc
    s_cmp_lg_u64 s[36:37], 0
    s_cbranch_scc1 A_KVC_4
    v_add_u32 v3, s31, v2
    v_add_u32 v4, s31, v6
    v_add_u32 v4, 1024, v4
    v_exp_f32 v44, v44
    v_exp_f32 v45, v45
    v_mfma_f32_32x32x16_bf16 v[76:91], v[40:43], v[64:67], v[76:91]
    v_exp_f32 v46, v46
    s_mov_b64 exec, s[38:39]
    ds_read_b128 v[28:31], v5 offset:8064
    ds_read_b128 v[32:35], v5 offset:8736
    s_mov_b64 exec, -1
    v_exp_f32 v47, v47
    v_exp_f32 v48, v48
    v_exp_f32 v49, v49
    s_waitcnt lgkmcnt(2)
    v_mfma_f32_32x32x16_bf16 v[60:75], v[20:23], v[92:95], 0
    v_exp_f32 v50, v50
    ds_read_b128 v[16:19], v3 offset:0
    ds_read_b64 v[24:25], v4 offset:0
    v_exp_f32 v51, v51
    v_cvt_pk_bf16_f32 v44, v44, v45
    v_cvt_pk_bf16_f32 v45, v46, v47
    s_add_u32 m0, s46, s32
    s_nop 0
    buffer_load_dwordx4 v2, s[12:15], s40 offen sc1 lds
    s_add_u32 s40, s40, s43
    s_add_u32 m0, s47, s32
    s_nop 0
    buffer_load_dwordx4 v2, s[12:15], s41 offen sc1 lds
    s_add_u32 s41, s41, s44
    s_add_u32 m0, s48, s32
    s_nop 0
    buffer_load_dwordx4 v2, s[12:15], s42 offen sc1 lds
    s_add_u32 s42, s42, s45
    v_cvt_pk_bf16_f32 v46, v48, v49
    v_mfma_f32_32x32x8_bf16 v[60:75], v[26:27], v[96:97], v[60:75]
    v_cvt_pk_bf16_f32 v47, v50, v51
    v_exp_f32 v52, v52
    v_exp_f32 v53, v53
    v_exp_f32 v54, v54
    v_exp_f32 v55, v55
    s_waitcnt lgkmcnt(2)
    v_mfma_f32_32x32x16_bf16 v[76:91], v[28:31], v[44:47], v[76:91]
    v_exp_f32 v56, v56
    v_exp_f32 v57, v57
    v_cvt_pk_bf16_f32 v48, v52, v53
    v_cvt_pk_bf16_f32 v49, v54, v55
    v_exp_f32 v58, v58
    v_exp_f32 v59, v59
    v_cvt_pk_bf16_f32 v50, v56, v57
    v_cvt_pk_bf16_f32 v51, v58, v59
    s_setprio 2
    v_exp_f32 v60, v60
    v_exp_f32 v61, v61
    v_mfma_f32_32x32x16_bf16 v[76:91], v[32:35], v[48:51], v[76:91]
    v_exp_f32 v62, v62
    s_mov_b64 exec, s[38:39]
    ds_read_b128 v[36:39], v5 offset:9408
    ds_read_b128 v[40:43], v5 offset:10080
    s_mov_b64 exec, -1
    v_exp_f32 v63, v63
    v_exp_f32 v64, v64
    v_exp_f32 v65, v65
    s_waitcnt lgkmcnt(2)
    v_mfma_f32_32x32x16_bf16 v[44:59], v[16:19], v[92:95], 0
    v_exp_f32 v66, v66
    ds_read_b128 v[20:23], v3 offset:1536
    ds_read_b64 v[26:27], v4 offset:1536
    v_exp_f32 v67, v67
    v_add_u32 v5, s31, v7
    s_add_u32 s31, s31, 23552
    s_cmp_ge_u32 s31, 94208
    s_cselect_b32 s31, 0, s31
    s_add_u32 s32, s32, 23552
    s_cmp_ge_u32 s32, 94208
    s_cselect_b32 s32, 0, s32
    v_cvt_pk_bf16_f32 v60, v60, v61
    v_cvt_pk_bf16_f32 v61, v62, v63
    v_cvt_pk_bf16_f32 v62, v64, v65
    v_mfma_f32_32x32x8_bf16 v[44:59], v[24:25], v[96:97], v[44:59]
    s_cmp_eq_u32 s30, s70
    s_cbranch_scc1 A_JOBC
A_JOBC_RET:
    v_cvt_pk_bf16_f32 v63, v66, v67
    v_exp_f32 v68, v68
    v_exp_f32 v69, v69
    v_exp_f32 v70, v70
    v_exp_f32 v71, v71
    s_waitcnt lgkmcnt(2)
    v_mfma_f32_32x32x16_bf16 v[76:91], v[36:39], v[60:63], v[76:91]
    v_exp_f32 v72, v72
    v_exp_f32 v73, v73
    s_cmp_eq_u32 s30, s58
    s_cbranch_scc1 A_JOBB
A_JOBB_RET:
    v_cvt_pk_bf16_f32 v64, v68, v69
    v_cvt_pk_bf16_f32 v65, v70, v71
    v_exp_f32 v74, v74
    v_exp_f32 v75, v75
    v_cvt_pk_bf16_f32 v66, v72, v73
    v_cvt_pk_bf16_f32 v67, v74, v75
    s_add_u32 s30, s30, 1
    s_cmp_lt_u32 s30, 8
    s_cbranch_scc1 A_LOOP
    s_setprio 0
    v_mfma_f32_32x32x16_bf16 v[76:91], v[40:43], v[64:67], v[76:91]
    s_load_dwordx2 s[94:95], s[0:1], 56
    s_load_dwordx2 s[96:97], s[0:1], 72
    s_load_dwordx2 s[98:99], s[0:1], 96
    v_lshrrev_b32 v126, 5, v1
    v_and_b32 v127, 31, v1
    s_lshr_b32 s24, s3, 1
    s_mul_i32 s24, s24, 5
    v_add_u32 v128, s24, v126
    v_lshrrev_b32 v129, 1, v128
    v_and_b32 v128, 1, v128
    s_and_b32 s24, s3, 1
    s_lshl_b32 s24, s24, 1
    v_lshrrev_b32 v130, 4, v127
    v_add_u32 v130, s24, v130
    v_mul_u32_u24 v130, 10, v130
    v_add_u32 v130, v130, v129
    v_lshlrev_b32 v130, 8, v130
    v_and_b32 v129, 15, v127
    v_lshl_add_u32 v130, v129, 4, v130
    v_lshl_add_u32 v130, v128, 3, v130
    v_add_u32 v130, 104704, v130
    v_mov_b32 v131, v84
    v_mov_b32 v132, v84
    s_nop 1
    v_permlane32_swap_b32 v131, v132
    v_rcp_f32 v132, v132
    s_nop 0
    v_mul_f32 v76, v76, v132
    v_mul_f32 v77, v77, v132
    v_mul_f32 v78, v78, v132
    v_mul_f32 v79, v79, v132
    v_mul_f32 v80, v80, v132
    v_mul_f32 v81, v81, v132
    v_mul_f32 v82, v82, v132
    v_mul_f32 v83, v83, v132
    v_mul_f32 v84, v84, v132
    v_mul_f32 v85, v85, v132
    v_mul_f32 v86, v86, v132
    v_mul_f32 v87, v87, v132
    v_cvt_pk_bf16_f32 v76, v76, v77
    v_cvt_pk_bf16_f32 v77, v78, v79
    v_cvt_pk_bf16_f32 v78, v80, v81
    v_cvt_pk_bf16_f32 v79, v82, v83
    v_cvt_pk_bf16_f32 v80, v84, v85
    v_cvt_pk_bf16_f32 v81, v86, v87
    ds_write_b64 v130, v[76:77]
    ds_write_b64 v130, v[78:79] offset:256
    s_mov_b32 exec_hi, 0
    ds_write_b64 v130, v[80:81] offset:512
    s_mov_b64 exec, -1
    v_lshlrev_b32 v128, 4, v0
    v_add_u32 v128, 104704, v128
    v_mul_u32_u24 v129, 410, v0
    v_lshrrev_b32 v129, 16, v129
    v_mul_u32_u24 v131, 17920, v129
    v_lshl_add_u32 v131, v0, 4, v131
    v_lshlrev_b32 v133, 4, v0
    v_add_u32 v133, 61952, v133
    v_mov_b32 v134, 0x40000000
    v_cmp_gt_u32 vcc, 128, v0
    s_nop 1
    v_cndmask_b32 v133, v134, v133, vcc
    s_mul_i32 s24, s20, 81920
    s_mul_i32 s25, s21, 2560
    s_add_u32 s24, s24, s25
    s_add_u32 s24, s24, 15728640
    s_cmp_lg_u32 s3, 7
    s_cbranch_scc1 A_NOFLJ
    s_cmp_eq_u32 s77, 1
    s_cbranch_scc1 A_FLJOK
    v_lshlrev_b32 v108, 7, v1
    v_and_b32 v109, 31, v1
    v_lshlrev_b32 v109, 10, v109
    s_and_b32 s26, s2, 7
    s_lshl_b32 s26, s26, 7
    s_add_u32 s26, s26, 753664
    s_mov_b32 s33, 0
A_FLJ:
    s_mov_b32 s25, 688128
    buffer_load_dword v100, v108, s[12:15], s25 offen sc1
    s_mov_b32 s25, 696320
    buffer_load_dword v101, v108, s[12:15], s25 offen sc1
    s_mov_b32 s25, 704512
    buffer_load_dword v102, v108, s[12:15], s25 offen sc1
    s_mov_b32 s25, 712704
    buffer_load_dword v103, v108, s[12:15], s25 offen sc1
    buffer_load_dword v104, v109, s[12:15], s26 offen sc1
    s_add_u32 s33, s33, 1
    s_waitcnt vmcnt(0)
    v_min_u32 v100, v100, v101
    v_min_u32 v102, v102, v103
    v_min_u32 v100, v100, v102
    v_min_u32 v100, v100, v104
    v_cmp_eq_u32 s[36:37], 0, v100
    s_cmp_gt_u32 s33, 200000
    s_cselect_b64 s[36:37], 0, s[36:37]
    s_cmp_lg_u64 s[36:37], 0
    s_cbranch_scc1 A_FLJ
A_FLJOK:
    s_nop 0
    v_cmp_ne_u32 s[36:37], s90, v104
    s_cmp_eq_u64 s[36:37], 0
    s_cselect_b32 s25, 1, 0
    v_mov_b32 v105, s25
    v_mov_b32 v106, 94336
    ds_write_b32 v106, v105
A_NOFLJ:
    s_nop 0
    v_mov_b32 v110, 94336
    s_waitcnt vmcnt(0) lgkmcnt(0)
    s_barrier
    ds_read_b32 v111, v110
    ds_read_b128 v[100:103], v128
    ds_read_b128 v[104:107], v128 offset:8192
    s_waitcnt lgkmcnt(0)
    v_readfirstlane_b32 s91, v111
    v_lshrrev_b32 v112, 4, v1
    v_lshlrev_b32 v112, 4, v112
    s_lshl_b32 s25, s3, 11
    s_add_u32 s25, s25, 94464
    v_add_u32 v112, s25, v112
    v_mov_b32 v113, s25
    s_cmp_lg_u32 s91, 0
    s_cbranch_scc1 XS_5
    buffer_store_dwordx4 v[100:103], v131, s[12:15], s24 offen sc1
    buffer_store_dwordx4 v[104:107], v133, s[12:15], s24 offen sc1
    s_branch XS_6
XS_5:
    buffer_store_dwordx4 v[100:103], v131, s[12:15], s24 offen
    buffer_store_dwordx4 v[104:107], v133, s[12:15], s24 offen
XS_6:
    s_lshl_b32 s24, s2, 7
    s_add_u32 s24, s24, 720896
    v_mov_b32 v108, 1
    v_mov_b32 v109, 0
    s_waitcnt vmcnt(0) lgkmcnt(0)
    s_barrier
    s_cmp_lg_u32 s3, 1
    s_cbranch_scc1 A_NOPUB
    s_mov_b64 exec, 1
    s_cmp_lg_u32 s91, 0
    s_cbranch_scc1 XS_7
    buffer_store_dword v108, v109, s[12:15], s24 offen sc1
    s_branch XS_8
XS_7:
    buffer_store_dword v108, v109, s[12:15], s24 offen
XS_8:
    s_mov_b64 exec, -1
A_NOPUB:
    s_nop 0
    s_branch M_PB
A_JOBA:
    s_nop 7
    s_sub_u32 s60, s56, 540
    s_mul_i32 s61, s56, 2428
    s_lshr_b32 s61, s61, 16
    s_mul_i32 s62, s60, 6554
    s_lshr_b32 s62, s62, 16
    s_cmp_lt_u32 s56, 540
    s_cselect_b32 s64, s52, s54
    s_cselect_b32 s65, s53, s55
    s_mov_b32 s63, 1280
    s_cselect_b32 s63, 3456, s63
    s_cselect_b32 s60, s56, s60
    s_cselect_b32 s61, s61, s62
    s_mov_b32 s62, 10
    s_cselect_b32 s62, 27, s62
    s_and_b32 s65, s65, 0xffff
    s_mov_b32 s66, 2211840
    s_mov_b32 s67, 0x00020000
    s_mul_i32 s62, s62, s61
    s_sub_u32 s62, s60, s62
    s_mul_i32 s73, s61, 86
    s_lshr_b32 s73, s73, 8
    s_mul_i32 s74, s73, 3
    s_sub_u32 s74, s61, s74
    s_mul_i32 s73, s73, 27
    s_lshr_b32 s73, s73, 2
    s_lshl_b32 s74, s74, 1
    s_add_u32 s73, s73, s74
    s_add_u32 s74, s73, 1
    s_lshl_b32 s75, s61, 1
    s_sub_u32 s75, s75, 96
    s_mul_i32 s24, s75, 86
    s_lshr_b32 s24, s24, 8
    s_add_u32 s24, s24, s75
    s_add_u32 s24, s24, 1
    s_mul_i32 s24, s24, 27
    s_lshr_b32 s24, s24, 2
    s_add_u32 s24, s24, 6
    s_add_u32 s75, s75, 1
    s_mul_i32 s25, s75, 86
    s_lshr_b32 s25, s25, 8
    s_add_u32 s25, s25, s75
    s_add_u32 s25, s25, 1
    s_mul_i32 s25, s25, 27
    s_lshr_b32 s25, s25, 2
    s_add_u32 s25, s25, 6
    s_cmp_ge_u32 s61, 48
    s_cselect_b32 s73, s24, s73
    s_cselect_b32 s74, s25, s74
    s_lshr_b32 s71, s61, 1
    s_mul_i32 s71, s71, 5
    s_and_b32 s72, s61, 1
    s_lshl_b32 s72, s72, 1
    s_add_u32 s71, s71, s72
    s_add_u32 s72, s71, 1
    s_sub_u32 s24, s61, 16
    s_mul_i32 s24, s24, 10
    s_add_u32 s24, s24, 4
    s_add_u32 s25, s24, 5
    s_cmp_ge_u32 s61, 16
    s_cselect_b32 s71, s24, s71
    s_cselect_b32 s72, s25, s72
    s_cmp_lt_u32 s56, 540
    s_cselect_b32 s73, s71, s73
    s_cselect_b32 s74, s72, s74
    s_mul_i32 s73, s73, s63
    s_mul_i32 s74, s74, s63
    s_lshl_b32 s73, s73, 4
    s_lshl_b32 s74, s74, 4
    s_lshl_b32 s24, s62, 7
    s_add_u32 s73, s73, s24
    s_add_u32 s74, s74, s24
    v_lshrrev_b32 v124, 3, v1
    v_and_b32 v125, 7, v1
    v_mul_u32_u24 v124, s63, v124
    v_lshl_add_u32 v124, v125, 4, v124
    s_lshl_b32 s24, s63, 3
    buffer_load_dwordx4 v[100:103], v124, s[64:67], s73 offen
    s_add_u32 s73, s73, s24
    buffer_load_dwordx4 v[104:107], v124, s[64:67], s73 offen
    buffer_load_dwordx4 v[108:111], v124, s[64:67], s74 offen
    s_add_u32 s74, s74, s24
    buffer_load_dwordx4 v[112:115], v124, s[64:67], s74 offen
    s_cmp_lt_u32 s56, 540
    s_mov_b32 s68, 55296
    s_cselect_b32 s68, 20480, s68
    s_mov_b32 s69, 6291456
    s_cselect_b32 s69, 3145728, s69
    s_mul_i32 s24, s62, s68
    s_lshl_b32 s24, s24, 2
    s_add_u32 s69, s69, s24
    s_lshl_b32 s24, s61, 10
    s_add_u32 s69, s69, s24
    s_branch A_JOBA_RET
A_JOBB:
    s_nop 7
    s_lshl_b32 s24, s3, 11
    s_add_u32 s24, s24, 94464
    v_add_u32 v124, s24, v2
    v_lshrrev_b32 v125, 2, v1
    v_and_b32 v126, 3, v1
    v_lshlrev_b32 v125, 7, v125
    v_lshl_add_u32 v125, v126, 3, v125
    v_add_u32 v125, s24, v125
    s_waitcnt lgkmcnt(0)
    ds_write_b128 v124, v[100:103]
    ds_write_b128 v124, v[104:107] offset:1024
    ds_read_b64_tr_b16 v[100:101], v125 offset:0
    ds_read_b64_tr_b16 v[104:105], v125 offset:32
    ds_read_b64_tr_b16 v[116:117], v125 offset:64
    ds_read_b64_tr_b16 v[120:121], v125 offset:96
    ds_write_b128 v124, v[108:111]
    ds_write_b128 v124, v[112:115] offset:1024
    ds_read_b64_tr_b16 v[102:103], v125 offset:0
    ds_read_b64_tr_b16 v[106:107], v125 offset:32
    ds_read_b64_tr_b16 v[118:119], v125 offset:64
    ds_read_b64_tr_b16 v[122:123], v125 offset:96
    s_branch A_JOBB_RET
A_JOBD:
    buffer_store_dwordx4 v[100:103], v2, s[12:15], s69 offen sc1
    s_add_u32 s69, s69, s68
    buffer_store_dwordx4 v[104:107], v2, s[12:15], s69 offen sc1
    s_add_u32 s69, s69, s68
    buffer_store_dwordx4 v[116:119], v2, s[12:15], s69 offen sc1
    s_add_u32 s69, s69, s68
    buffer_store_dwordx4 v[120:123], v2, s[12:15], s69 offen sc1
    s_nop 1
    s_branch A_JOBD_RET
A_JOBG:
    s_sub_u32 s24, s30, 3
    s_cmp_ge_u32 s3, 4
    s_cbranch_scc1 A_JOBG2
    s_cmp_lt_u32 s30, 6
    s_cbranch_scc1 A_JOBG_RET
    v_lshrrev_b32 v124, 4, v1
    v_and_b32 v126, 15, v1
    v_mul_u32_u24 v126, 1280, v126
    v_lshl_add_u32 v126, v124, 3, v126
    s_lshl_b32 s24, s20, 2
    s_add_u32 s24, s24, s3
    s_mul_i32 s25, s21, 160
    s_mul_i32 s26, s24, 20480
    s_add_u32 s26, s26, s25
    s_mov_b32 s16, s92
    s_and_b32 s17, s93, 0xffff
    s_mov_b32 s18, 2621440
    s_mov_b32 s19, 0x00020000
    s_cmp_eq_u32 s30, 7
    s_cbranch_scc1 A_JOBG3
    buffer_load_dwordx2 v[200:201], v126, s[16:19], s26 offen offset:0
    buffer_load_dwordx2 v[202:203], v126, s[16:19], s26 offen offset:32
    buffer_load_dwordx2 v[204:205], v126, s[16:19], s26 offen offset:64
    s_branch A_JOBG_RET
A_JOBG3:
    buffer_load_dwordx2 v[206:207], v126, s[16:19], s26 offen offset:96
    buffer_load_dwordx2 v[208:209], v126, s[16:19], s26 offen offset:128
    s_branch A_JOBG_RET
A_JOBG2:
    s_sub_u32 s27, s3, 4
    s_mul_i32 s25, s21, 5
    s_add_u32 s25, s25, s24
    s_mul_i32 s25, s25, 20480
    s_lshl_b32 s26, s27, 11
    s_add_u32 s25, s25, s26
    s_add_u32 s25, s25, 2097152
    s_mul_i32 s26, s27, 10240
    s_lshl_b32 s24, s24, 11
    s_add_u32 s26, s26, s24
    s_add_u32 m0, s26, 122880
    s_nop 0
    buffer_load_dwordx4 v2, s[12:15], s25 offen lds
    buffer_load_dwordx4 v2, s[12:15], s25 offen offset:1024 lds
    s_branch A_JOBG_RET
A_JOBM:
    s_cmp_eq_u32 s30, 2
    s_cbranch_scc1 A_JOBM2
    s_lshl_b32 s24, s2, 10
    s_add_u32 s25, s24, 5120
    buffer_load_dwordx4 v[100:103], v2, s[12:15], s25 offen
    s_add_u32 s25, s24, 20480
    buffer_load_dwordx4 v[104:107], v2, s[12:15], s25 offen
    s_add_u32 s25, s24, 35840
    buffer_load_dwordx4 v[108:111], v2, s[12:15], s25 offen
    s_add_u32 s25, s24, 51200
    buffer_load_dwordx4 v[112:115], v2, s[12:15], s25 offen
    s_mov_b32 s49, 2
    s_branch A_JOBM_RET
A_JOBM2:
    s_nop 7
    v_add_f32 v100, v100, v104
    v_add_f32 v108, v108, v112
    v_add_f32 v101, v101, v105
    v_add_f32 v109, v109, v113
    v_add_f32 v102, v102, v106
    v_add_f32 v110, v110, v114
    v_add_f32 v103, v103, v107
    v_add_f32 v111, v111, v115
    v_add_f32 v100, v100, v108
    v_add_f32 v101, v101, v109
    v_add_f32 v102, v102, v110
    v_add_f32 v103, v103, v111
    v_cvt_pk_bf16_f32 v100, v100, v100
    v_and_b32 v100, 0xffff0000, v100
    v_cvt_pk_bf16_f32 v101, v101, v101
    v_and_b32 v101, 0xffff0000, v101
    v_cvt_pk_bf16_f32 v102, v102, v102
    v_and_b32 v102, 0xffff0000, v102
    v_cvt_pk_bf16_f32 v103, v103, v103
    v_and_b32 v103, 0xffff0000, v103
    s_lshl_b32 s24, s2, 6
    v_add_u32 v104, s24, v1
    v_subrev_u32 v104, 320, v104
    v_cmp_gt_u32 vcc, 160, v104
    s_nop 1
    v_cndmask_b32 v104, 0, 1.0, vcc
    v_add_f32 v100, v104, v100
    v_add_f32 v101, v104, v101
    v_add_f32 v102, v104, v102
    v_add_f32 v103, v104, v103
    v_cvt_pk_bf16_f32 v100, v100, v100
    v_and_b32 v100, 0xffff0000, v100
    v_cvt_pk_bf16_f32 v101, v101, v101
    v_and_b32 v101, 0xffff0000, v101
    v_cvt_pk_bf16_f32 v102, v102, v102
    v_and_b32 v102, 0xffff0000, v102
    v_cvt_pk_bf16_f32 v103, v103, v103
    v_and_b32 v103, 0xffff0000, v103
    s_lshl_b32 s24, s2, 10
    s_add_u32 s24, s24, 65536
    buffer_store_dwordx4 v[100:103], v2, s[12:15], s24 offen sc1
    s_nop 1
    s_branch A_JOBM_RET
A_JOBH:
    s_lshr_b32 s24, s2, 3
    s_lshl_b32 s25, s3, 5
    s_add_u32 s24, s24, s25
    s_lshl_b32 s24, s24, 6
    v_add_u32 v134, s24, v1
    v_lshlrev_b32 v134, 7, v134
    s_mov_b32 s24, 3145728
    buffer_load_dword v135, v134, s[12:15], s24 offen
    s_branch A_JOBH_RET
A_JOBE:
    s_lshr_b32 s24, s2, 3
    s_lshl_b32 s25, s3, 5
    s_add_u32 s24, s24, s25
    s_lshl_b32 s24, s24, 6
    v_add_u32 v134, s24, v1
    v_cmp_gt_u32 vcc, 6400, v134
    v_lshlrev_b32 v134, 7, v134
    v_mov_b32 v135, 0x40000000
    v_cndmask_b32 v134, v135, v134, vcc
    s_mov_b32 s24, 2097152
    buffer_load_dword v135, v134, s[12:15], s24 offen
    s_branch A_JOBE_RET
A_JOBF:
    s_and_b32 s24, s3, 3
    s_cmp_ge_u32 s3, 4
    s_cbranch_scc1 A_JOBF2
    s_lshl_b32 s25, s20, 2
    s_add_u32 s25, s25, s24
    s_mul_i32 s26, s25, 20480
    v_lshlrev_b32 v134, 7, v1
    s_mul_i32 s27, s21, 2560
    s_add_u32 s27, s27, s26
    s_add_u32 s27, s27, 15728640
    s_mov_b32 exec_lo, 0xfffff
    s_mov_b32 exec_hi, 0
    buffer_load_dword v135, v134, s[12:15], s27 offen
    s_lshl_b32 s27, s21, 11
    s_add_u32 s27, s27, s26
    s_add_u32 s27, s27, 18874368
    s_mov_b32 exec_lo, 0xffff
    buffer_load_dword v135, v134, s[12:15], s27 offen
    s_lshl_b32 s27, s21, 9
    s_add_u32 s27, s27, s26
    s_add_u32 s27, s27, 18890752
    s_mov_b32 exec_lo, 0xf
    buffer_load_dword v135, v134, s[12:15], s27 offen
    s_mov_b64 exec, -1
    s_branch A_JOBF_RET
A_JOBF2:
    s_and_b32 s25, s2, 7
    s_lshl_b32 s25, s25, 1
    s_bfe_u32 s26, s2, 0x10003
    s_add_u32 s25, s25, s26
    s_lshl_b32 s25, s25, 3
    s_lshl_b32 s26, s24, 1
    s_add_u32 s25, s25, s26
    s_mul_i32 s25, s25, 55296
    s_lshr_b32 s26, s2, 4
    s_mul_i32 s27, s26, 3072
    s_add_u32 s27, s27, s25
    s_add_u32 s27, s27, 22020096
    v_and_b32 v134, 31, v1
    v_lshlrev_b32 v134, 7, v134
    v_lshrrev_b32 v135, 5, v1
    v_mul_u32_u24 v135, 55296, v135
    v_add_u32 v134, v134, v135
    s_mov_b32 exec_lo, 0xffffff
    s_mov_b32 exec_hi, 0xffffff
    buffer_load_dword v135, v134, s[12:15], s27 offen
    s_lshr_b32 s27, s26, 2
    s_sub_u32 s27, s26, s27
    s_sub_u32 s27, s27, 1
    s_max_i32 s27, s27, 0
    s_and_b32 s26, s27, 1
    s_mul_i32 s26, s26, 55296
    s_lshr_b32 s27, s27, 1
    s_lshl_b32 s27, s27, 10
    s_add_u32 s27, s27, s26
    s_add_u32 s27, s27, s25
    s_add_u32 s27, s27, 22069248
    s_mov_b32 exec_lo, 0xff
    s_mov_b32 exec_hi, 0
    buffer_load_dword v135, v134, s[12:15], s27 offen
    s_mov_b64 exec, -1
    s_branch A_JOBF_RET
A_JOBC:
    s_nop 7
    s_cmp_eq_u32 s3, 7
    s_cbranch_scc1 A_JOBC7
    s_lshl_b32 s24, s2, 7
    s_add_u32 s24, s24, 688128
    v_mov_b32 v124, 1
    v_mov_b32 v125, 0
    s_mov_b64 exec, 1
    buffer_store_dword v124, v125, s[12:15], s24 offen sc1
    s_mov_b64 exec, -1
    s_branch A_JOBC_RET
A_JOBC7:
    s_cmp_eq_u32 s30, 7
    s_cbranch_scc1 A_JOBC7B
    v_lshlrev_b32 v124, 7, v1
    s_mov_b32 s24, 688128
    buffer_load_dword v100, v124, s[12:15], s24 offen sc1
    s_mov_b32 s24, 696320
    buffer_load_dword v101, v124, s[12:15], s24 offen sc1
    s_mov_b32 s24, 704512
    buffer_load_dword v102, v124, s[12:15], s24 offen sc1
    s_mov_b32 s24, 712704
    buffer_load_dword v103, v124, s[12:15], s24 offen sc1
    v_and_b32 v124, 31, v1
    v_lshlrev_b32 v124, 10, v124
    s_and_b32 s24, s2, 7
    s_lshl_b32 s24, s24, 7
    s_add_u32 s24, s24, 753664
    buffer_load_dword v104, v124, s[12:15], s24 offen sc1
    s_mov_b32 s70, 7
    s_branch A_JOBC_RET
A_JOBC7B:
    s_waitcnt vmcnt(3)
    v_min_u32 v100, v100, v101
    v_min_u32 v102, v102, v103
    v_min_u32 v100, v100, v102
    v_min_u32 v100, v100, v104
    v_cmp_eq_u32 s[36:37], 0, v100
    s_cmp_eq_u64 s[36:37], 0
    s_cselect_b32 s77, 1, 0
    s_branch A_JOBC_RET
A_SLOW:
    s_nop 2
    s_waitcnt lgkmcnt(0)
    s_mov_b32 s30, 0
    v_mov_b32 v132, 0xff800000
    v_add_u32 v128, 70656, v2
    v_add_u32 v129, 71680, v6
    s_sub_u32 s60, s40, s43
    s_sub_u32 s61, s41, s44
    s_sub_u32 s62, s42, s45
A_SLOWL:
    s_barrier
    s_add_u32 m0, s46, 70656
    s_nop 0
    buffer_load_dwordx4 v2, s[12:15], s60 offen sc1 lds
    s_add_u32 s60, s60, s43
    s_add_u32 m0, s47, 70656
    s_nop 0
    buffer_load_dwordx4 v2, s[12:15], s61 offen sc1 lds
    s_add_u32 s61, s61, s44
    s_add_u32 m0, s48, 70656
    s_nop 0
    buffer_load_dwordx4 v2, s[12:15], s62 offen sc1 lds
    s_add_u32 s62, s62, s45
    s_waitcnt vmcnt(0)
    s_barrier
    ds_read_b128 v[100:103], v128 offset:0
    ds_read_b64 v[104:105], v129 offset:0
    s_waitcnt lgkmcnt(0)
    v_mfma_f32_32x32x16_bf16 v[44:59], v[100:103], v[92:95], 0
    v_mfma_f32_32x32x8_bf16 v[44:59], v[104:105], v[96:97], v[44:59]
    s_nop 11
    v_max3_f32 v132, v132, v44, v45
    v_max3_f32 v132, v132, v46, v47
    v_max3_f32 v132, v132, v48, v49
    v_max3_f32 v132, v132, v50, v51
    v_max3_f32 v132, v132, v52, v53
    v_max3_f32 v132, v132, v54, v55
    v_max3_f32 v132, v132, v56, v57
    v_max3_f32 v132, v132, v58, v59
    ds_read_b128 v[100:103], v128 offset:1536
    ds_read_b64 v[104:105], v129 offset:1536
    s_waitcnt lgkmcnt(0)
    v_mfma_f32_32x32x16_bf16 v[44:59], v[100:103], v[92:95], 0
    v_mfma_f32_32x32x8_bf16 v[44:59], v[104:105], v[96:97], v[44:59]
    s_nop 11
    v_max3_f32 v132, v132, v44, v45
    v_max3_f32 v132, v132, v46, v47
    v_max3_f32 v132, v132, v48, v49
    v_max3_f32 v132, v132, v50, v51
    v_max3_f32 v132, v132, v52, v53
    v_max3_f32 v132, v132, v54, v55
    v_max3_f32 v132, v132, v56, v57
    v_max3_f32 v132, v132, v58, v59
    ds_read_b128 v[100:103], v128 offset:3072
    ds_read_b64 v[104:105], v129 offset:3072
    s_waitcnt lgkmcnt(0)
    v_mfma_f32_32x32x16_bf16 v[44:59], v[100:103], v[92:95], 0
    v_mfma_f32_32x32x8_bf16 v[44:59], v[104:105], v[96:97], v[44:59]
    s_nop 11
    v_max3_f32 v132, v132, v44, v45
    v_max3_f32 v132, v132, v46, v47
    v_max3_f32 v132, v132, v48, v49
    v_max3_f32 v132, v132, v50, v51
    v_max3_f32 v132, v132, v52, v53
    v_max3_f32 v132, v132, v54, v55
    v_max3_f32 v132, v132, v56, v57
    v_max3_f32 v132, v132, v58, v59
    ds_read_b128 v[100:103], v128 offset:4608
    ds_read_b64 v[104:105], v129 offset:4608
    s_waitcnt lgkmcnt(0)
    v_mfma_f32_32x32x16_bf16 v[44:59], v[100:103], v[92:95], 0
    v_mfma_f32_32x32x8_bf16 v[44:59], v[104:105], v[96:97], v[44:59]
    s_nop 11
    v_max3_f32 v132, v132, v44, v45
    v_max3_f32 v132, v132, v46, v47
    v_max3_f32 v132, v132, v48, v49
    v_max3_f32 v132, v132, v50, v51
    v_max3_f32 v132, v132, v52, v53
    v_max3_f32 v132, v132, v54, v55
    v_max3_f32 v132, v132, v56, v57
    v_max3_f32 v132, v132, v58, v59
    ds_read_b128 v[100:103], v128 offset:6144
    ds_read_b64 v[104:105], v129 offset:6144
    s_waitcnt lgkmcnt(0)
    v_mfma_f32_32x32x16_bf16 v[44:59], v[100:103], v[92:95], 0
    v_mfma_f32_32x32x8_bf16 v[44:59], v[104:105], v[96:97], v[44:59]
    s_nop 11
    v_max3_f32 v132, v132, v44, v45
    v_max3_f32 v132, v132, v46, v47
    v_max3_f32 v132, v132, v48, v49
    v_max3_f32 v132, v132, v50, v51
    v_max3_f32 v132, v132, v52, v53
    v_max3_f32 v132, v132, v54, v55
    v_max3_f32 v132, v132, v56, v57
    v_max3_f32 v132, v132, v58, v59
    ds_read_b128 v[100:103], v128 offset:7680
    ds_read_b64 v[104:105], v129 offset:7680
    s_waitcnt lgkmcnt(0)
    v_mfma_f32_32x32x16_bf16 v[44:59], v[100:103], v[92:95], 0
    v_mfma_f32_32x32x8_bf16 v[44:59], v[104:105], v[96:97], v[44:59]
    s_nop 11
    v_max3_f32 v132, v132, v44, v45
    v_max3_f32 v132, v132, v46, v47
    v_max3_f32 v132, v132, v48, v49
    v_max3_f32 v132, v132, v50, v51
    v_max3_f32 v132, v132, v52, v53
    v_max3_f32 v132, v132, v54, v55
    v_max3_f32 v132, v132, v56, v57
    v_max3_f32 v132, v132, v58, v59
    ds_read_b128 v[100:103], v128 offset:9216
    ds_read_b64 v[104:105], v129 offset:9216
    s_waitcnt lgkmcnt(0)
    v_mfma_f32_32x32x16_bf16 v[44:59], v[100:103], v[92:95], 0
    v_mfma_f32_32x32x8_bf16 v[44:59], v[104:105], v[96:97], v[44:59]
    s_nop 11
    v_max3_f32 v132, v132, v44, v45
    v_max3_f32 v132, v132, v46, v47
    v_max3_f32 v132, v132, v48, v49
    v_max3_f32 v132, v132, v50, v51
    v_max3_f32 v132, v132, v52, v53
    v_max3_f32 v132, v132, v54, v55
    v_max3_f32 v132, v132, v56, v57
    v_max3_f32 v132, v132, v58, v59
    ds_read_b128 v[100:103], v128 offset:10752
    ds_read_b64 v[104:105], v129 offset:10752
    s_waitcnt lgkmcnt(0)
    v_mfma_f32_32x32x16_bf16 v[44:59], v[100:103], v[92:95], 0
    v_mfma_f32_32x32x8_bf16 v[44:59], v[104:105], v[96:97], v[44:59]
    s_nop 11
    v_max3_f32 v132, v132, v44, v45
    v_max3_f32 v132, v132, v46, v47
    v_max3_f32 v132, v132, v48, v49
    v_max3_f32 v132, v132, v50, v51
    v_max3_f32 v132, v132, v52, v53
    v_max3_f32 v132, v132, v54, v55
    v_max3_f32 v132, v132, v56, v57
    v_max3_f32 v132, v132, v58, v59
    s_add_u32 s30, s30, 1
    s_cmp_lt_u32 s30, 8
    s_cbranch_scc1 A_SLOWL
    v_mov_b32 v133, v132
    s_nop 1
    v_permlane32_swap_b32 v132, v133
    v_max_f32 v132, v132, v133
    v_sub_f32 v132, 0, v132
    v_and_b32 v128, 0xffff0000, v132
    v_sub_f32 v132, v132, v128
    v_and_b32 v129, 0xffff0000, v132
    v_sub_f32 v132, v132, v129
    s_mov_b32 exec_lo, 0
    v_cvt_pk_bf16_f32 v96, v128, v129
    v_cvt_pk_bf16_f32 v97, v132, 0
    s_mov_b64 exec, -1
    s_barrier
    s_nop 0
    s_branch A_RESUME
M_END:
    s_endpgm
.p2align 6
M_PB:
    s_waitcnt lgkmcnt(0)
    s_and_b32 s40, s2, 7
    s_lshr_b32 s41, s2, 3
    s_lshl_b32 s22, s40, 1
    s_and_b32 s23, s41, 1
    s_add_u32 s22, s22, s23
    s_lshr_b32 s29, s41, 1
    s_mul_i32 s23, s29, 27
    s_lshr_b32 s23, s23, 2
    v_lshlrev_b32 v3, 4, v1
    s_cmp_ge_u32 s3, 4
    s_cbranch_scc1 M_LOADER
    v_add_u32 v4, 61440, v3
    v_add_u32 v5, 122880, v3
    v_lshrrev_b32 v6, 4, v1
    v_lshlrev_b32 v7, 3, v6
    v_lshlrev_b32 v8, 4, v6
    v_and_b32 v9, 15, v1
    v_mul_u32_u24 v9, 1280, v9
    v_add_u32 v9, v9, v7
    s_lshl_b32 s24, s20, 2
    s_add_u32 s24, s24, s3
    s_mul_i32 s28, s21, 160
    s_mul_i32 s42, s24, 20480
    s_add_u32 s42, s42, s28
    s_lshl_b32 s26, s3, 11
    v_add_u32 v10, s26, v3
    v_add_u32 v11, s26, v4
    v_add_u32 v12, s26, v5
    v_mov_b32 v13, 0
    s_mov_b32 s16, s94
    s_and_b32 s17, s95, 0xffff
    s_mov_b32 s18, 3456
    s_mov_b32 s19, 0x00020000
    s_lshl_b32 s44, s23, 5
    buffer_load_dwordx2 v[218:219], v7, s[16:19], s44 offen offset:0
    buffer_load_dwordx2 v[220:221], v7, s[16:19], s44 offen offset:32
    buffer_load_dwordx2 v[222:223], v7, s[16:19], s44 offen offset:64
    buffer_load_dwordx2 v[224:225], v7, s[16:19], s44 offen offset:96
    buffer_load_dwordx2 v[226:227], v7, s[16:19], s44 offen offset:128
    buffer_load_dwordx2 v[228:229], v7, s[16:19], s44 offen offset:160
    buffer_load_dwordx2 v[230:231], v7, s[16:19], s44 offen offset:192
    v_mul_u32_u24 v14, 13, v1
    v_lshrrev_b32 v14, 8, v14
    v_mul_u32_u24 v15, 20, v14
    v_sub_u32 v15, v1, v15
    v_mul_u32_u24 v14, 2560, v14
    v_lshl_add_u32 v14, v15, 4, v14
    s_lshl_b32 s30, s28, 1
    s_add_u32 s30, s30, 65536
    s_lshl_b32 s31, s3, 10
    s_add_u32 m0, s31, 49152
    v_add_u32 v15, 2048, v3
    buffer_load_dwordx4 v14, s[12:15], s30 offen sc1 lds
    v_mov_b32 v14, 0x40000000
    v_cmp_gt_u32 vcc, 32, v1
    s_nop 1
    v_cndmask_b32 v15, v14, v15, vcc
    s_mov_b32 s30, 68096
    buffer_load_dwordx4 v[16:19], v3, s[12:15], s30 offen offset:0 sc1
    buffer_load_dwordx4 v[20:23], v3, s[12:15], s30 offen offset:2560 sc1
    buffer_load_dwordx4 v[24:27], v3, s[12:15], s30 offen offset:1024 sc1
    buffer_load_dwordx4 v[28:31], v3, s[12:15], s30 offen offset:3584 sc1
    buffer_load_dwordx4 v[32:35], v15, s[12:15], s30 offen offset:0 sc1
    buffer_load_dwordx4 v[36:39], v15, s[12:15], s30 offen offset:2560 sc1
    v_mov_b32 v112, 0
    v_mov_b32 v113, 0
    v_mov_b32 v114, 0
    v_mov_b32 v115, 0
    v_mov_b32 v116, 0
    v_mov_b32 v117, 0
    v_mov_b32 v118, 0
    v_mov_b32 v119, 0
    v_mov_b32 v120, 0
    v_mov_b32 v121, 0
    v_mov_b32 v122, 0
    v_mov_b32 v123, 0
    v_mov_b32 v124, 0
    v_mov_b32 v125, 0
    v_mov_b32 v126, 0
    v_mov_b32 v127, 0
    v_mov_b32 v128, 0
    v_mov_b32 v129, 0
    v_mov_b32 v130, 0
    v_mov_b32 v131, 0
    v_mov_b32 v212, 0
    v_mov_b32 v213, 0
    v_mov_b32 v214, 0
    v_mov_b32 v215, 0
    v_mov_b32 v216, 0
    v_add_u32 v14, s31, v8
    s_waitcnt vmcnt(0)
    ds_read_b128 v[140:143], v14 offset:49152
    ds_read_b128 v[180:183], v14 offset:49472
    ds_read_b128 v[160:163], v14 offset:49792
    ds_read_b128 v[144:147], v14 offset:49216
    ds_read_b128 v[184:187], v14 offset:49536
    ds_read_b128 v[164:167], v14 offset:49856
    ds_read_b128 v[148:151], v14 offset:49280
    ds_read_b128 v[188:191], v14 offset:49600
    ds_read_b128 v[168:171], v14 offset:49920
    ds_read_b128 v[152:155], v14 offset:49344
    ds_read_b128 v[192:195], v14 offset:49664
    ds_read_b128 v[172:175], v14 offset:49984
    ds_read_b128 v[156:159], v14 offset:49408
    ds_read_b128 v[196:199], v14 offset:49728
    ds_read_b128 v[176:179], v14 offset:50048
    v_add_f32 v212, v212, v20
    v_fmac_f32 v213, v20, v20
    v_fmac_f32 v214, v20, v16
    v_add_f32 v215, v215, v16
    v_fmac_f32 v216, v16, v16
    v_add_f32 v212, v212, v21
    v_fmac_f32 v213, v21, v21
    v_fmac_f32 v214, v21, v17
    v_add_f32 v215, v215, v17
    v_fmac_f32 v216, v17, v17
    v_add_f32 v212, v212, v22
    v_fmac_f32 v213, v22, v22
    v_fmac_f32 v214, v22, v18
    v_add_f32 v215, v215, v18
    v_fmac_f32 v216, v18, v18
    v_add_f32 v212, v212, v23
    v_fmac_f32 v213, v23, v23
    v_fmac_f32 v214, v23, v19
    v_add_f32 v215, v215, v19
    v_fmac_f32 v216, v19, v19
    v_add_f32 v212, v212, v28
    v_fmac_f32 v213, v28, v28
    v_fmac_f32 v214, v28, v24
    v_add_f32 v215, v215, v24
    v_fmac_f32 v216, v24, v24
    v_add_f32 v212, v212, v29
    v_fmac_f32 v213, v29, v29
    v_fmac_f32 v214, v29, v25
    v_add_f32 v215, v215, v25
    v_fmac_f32 v216, v25, v25
    v_add_f32 v212, v212, v30
    v_fmac_f32 v213, v30, v30
    v_fmac_f32 v214, v30, v26
    v_add_f32 v215, v215, v26
    v_fmac_f32 v216, v26, v26
    v_add_f32 v212, v212, v31
    v_fmac_f32 v213, v31, v31
    v_fmac_f32 v214, v31, v27
    v_add_f32 v215, v215, v27
    v_fmac_f32 v216, v27, v27
    v_add_f32 v212, v212, v36
    v_fmac_f32 v213, v36, v36
    v_fmac_f32 v214, v36, v32
    v_add_f32 v215, v215, v32
    v_fmac_f32 v216, v32, v32
    v_add_f32 v212, v212, v37
    v_fmac_f32 v213, v37, v37
    v_fmac_f32 v214, v37, v33
    v_add_f32 v215, v215, v33
    v_fmac_f32 v216, v33, v33
    v_add_f32 v212, v212, v38
    v_fmac_f32 v213, v38, v38
    v_fmac_f32 v214, v38, v34
    v_add_f32 v215, v215, v34
    v_fmac_f32 v216, v34, v34
    v_add_f32 v212, v212, v39
    v_fmac_f32 v213, v39, v39
    v_fmac_f32 v214, v39, v35
    v_add_f32 v215, v215, v35
    v_fmac_f32 v216, v35, v35
    v_add_f32_dpp v212, v212, v212 row_ror:8 row_mask:0xf bank_mask:0xf
    s_nop 1
    v_add_f32_dpp v212, v212, v212 row_ror:4 row_mask:0xf bank_mask:0xf
    s_nop 1
    v_add_f32_dpp v212, v212, v212 row_ror:2 row_mask:0xf bank_mask:0xf
    s_nop 1
    v_add_f32_dpp v212, v212, v212 row_ror:1 row_mask:0xf bank_mask:0xf
    v_mov_b32 v15, v212
    s_nop 1
    v_permlane16_swap_b32 v212, v15
    v_add_f32 v212, v212, v15
    v_mov_b32 v15, v212
    s_nop 1
    v_permlane32_swap_b32 v212, v15
    v_add_f32 v212, v212, v15
    v_add_f32_dpp v213, v213, v213 row_ror:8 row_mask:0xf bank_mask:0xf
    s_nop 1
    v_add_f32_dpp v213, v213, v213 row_ror:4 row_mask:0xf bank_mask:0xf
    s_nop 1
    v_add_f32_dpp v213, v213, v213 row_ror:2 row_mask:0xf bank_mask:0xf
    s_nop 1
    v_add_f32_dpp v213, v213, v213 row_ror:1 row_mask:0xf bank_mask:0xf
    v_mov_b32 v15, v213
    s_nop 1
    v_permlane16_swap_b32 v213, v15
    v_add_f32 v213, v213, v15
    v_mov_b32 v15, v213
    s_nop 1
    v_permlane32_swap_b32 v213, v15
    v_add_f32 v213, v213, v15
    v_add_f32_dpp v214, v214, v214 row_ror:8 row_mask:0xf bank_mask:0xf
    s_nop 1
    v_add_f32_dpp v214, v214, v214 row_ror:4 row_mask:0xf bank_mask:0xf
    s_nop 1
    v_add_f32_dpp v214, v214, v214 row_ror:2 row_mask:0xf bank_mask:0xf
    s_nop 1
    v_add_f32_dpp v214, v214, v214 row_ror:1 row_mask:0xf bank_mask:0xf
    v_mov_b32 v15, v214
    s_nop 1
    v_permlane16_swap_b32 v214, v15
    v_add_f32 v214, v214, v15
    v_mov_b32 v15, v214
    s_nop 1
    v_permlane32_swap_b32 v214, v15
    v_add_f32 v214, v214, v15
    v_add_f32_dpp v215, v215, v215 row_ror:8 row_mask:0xf bank_mask:0xf
    s_nop 1
    v_add_f32_dpp v215, v215, v215 row_ror:4 row_mask:0xf bank_mask:0xf
    s_nop 1
    v_add_f32_dpp v215, v215, v215 row_ror:2 row_mask:0xf bank_mask:0xf
    s_nop 1
    v_add_f32_dpp v215, v215, v215 row_ror:1 row_mask:0xf bank_mask:0xf
    v_mov_b32 v15, v215
    s_nop 1
    v_permlane16_swap_b32 v215, v15
    v_add_f32 v215, v215, v15
    v_mov_b32 v15, v215
    s_nop 1
    v_permlane32_swap_b32 v215, v15
    v_add_f32 v215, v215, v15
    v_add_f32_dpp v216, v216, v216 row_ror:8 row_mask:0xf bank_mask:0xf
    s_nop 1
    v_add_f32_dpp v216, v216, v216 row_ror:4 row_mask:0xf bank_mask:0xf
    s_nop 1
    v_add_f32_dpp v216, v216, v216 row_ror:2 row_mask:0xf bank_mask:0xf
    s_nop 1
    v_add_f32_dpp v216, v216, v216 row_ror:1 row_mask:0xf bank_mask:0xf
    v_mov_b32 v15, v216
    s_nop 1
    v_permlane16_swap_b32 v216, v15
    v_add_f32 v216, v216, v15
    v_mov_b32 v15, v216
    s_nop 1
    v_permlane32_swap_b32 v216, v15
    v_add_f32 v216, v216, v15
    s_mov_b32 s56, 0
    s_mov_b32 s57, 122880
    s_mov_b32 s58, 10
    v_add_u32 v11, s57, v3
    v_add_u32 v12, s56, v10
    s_add_u32 s56, s56, 8192
    s_cmp_ge_u32 s56, 49152
    s_cselect_b32 s56, 0, s56
    s_add_u32 s57, s57, 10240
    s_cmp_ge_u32 s57, 163840
    s_cselect_b32 s57, 61440, s57
    s_sub_u32 s58, s58, 1
    s_waitcnt lgkmcnt(0)
    s_barrier
    ds_read_b128 v[96:99], v12 offset:0
    ds_read_b128 v[16:19], v11 offset:0
    ds_read_b128 v[20:23], v11 offset:2048
    ds_read_b128 v[24:27], v11 offset:4096
    ds_read_b128 v[28:31], v11 offset:6144
    ds_read_b128 v[32:35], v11 offset:8192
    ds_read_b128 v[100:103], v12 offset:1024
    ds_read_b128 v[36:39], v11 offset:1024
    ds_read_b128 v[40:43], v11 offset:3072
    ds_read_b128 v[44:47], v11 offset:5120
    ds_read_b128 v[48:51], v11 offset:7168
    ds_read_b128 v[52:55], v11 offset:9216
    v_add_u32 v11, s57, v3
    v_add_u32 v12, s56, v10
    s_add_u32 s56, s56, 8192
    s_cmp_ge_u32 s56, 49152
    s_cselect_b32 s56, 0, s56
    s_add_u32 s57, s57, 10240
    s_cmp_ge_u32 s57, 163840
    s_cselect_b32 s57, 61440, s57
    s_sub_u32 s58, s58, 1
CB_L:
    s_waitcnt lgkmcnt(0)
    s_barrier
    v_mfma_f32_16x16x32_bf16 v[112:115], v[16:19], v[96:99], v[112:115]
    ds_read_b128 v[104:107], v12 offset:0
    ds_read_b128 v[56:59], v11 offset:0
    ds_read_b128 v[60:63], v11 offset:2048
    v_mfma_f32_16x16x32_bf16 v[116:119], v[20:23], v[96:99], v[116:119]
    ds_read_b128 v[64:67], v11 offset:4096
    ds_read_b128 v[68:71], v11 offset:6144
    ds_read_b128 v[72:75], v11 offset:8192
    v_mfma_f32_16x16x32_bf16 v[120:123], v[24:27], v[96:99], v[120:123]
    ds_read_b128 v[108:111], v12 offset:1024
    ds_read_b128 v[76:79], v11 offset:1024
    ds_read_b128 v[80:83], v11 offset:3072
    v_mfma_f32_16x16x32_bf16 v[124:127], v[28:31], v[96:99], v[124:127]
    ds_read_b128 v[84:87], v11 offset:5120
    ds_read_b128 v[88:91], v11 offset:7168
    ds_read_b128 v[92:95], v11 offset:9216
    v_mfma_f32_16x16x32_bf16 v[128:131], v[32:35], v[96:99], v[128:131]
    v_add_u32 v11, s57, v3
    v_add_u32 v12, s56, v10
    s_add_u32 s56, s56, 8192
    v_mfma_f32_16x16x32_bf16 v[112:115], v[36:39], v[100:103], v[112:115]
    s_cmp_ge_u32 s56, 49152
    s_cselect_b32 s56, 0, s56
    s_add_u32 s57, s57, 10240
    v_mfma_f32_16x16x32_bf16 v[116:119], v[40:43], v[100:103], v[116:119]
    s_cmp_ge_u32 s57, 163840
    s_cselect_b32 s57, 61440, s57
    s_sub_u32 s58, s58, 1
    v_mfma_f32_16x16x32_bf16 v[120:123], v[44:47], v[100:103], v[120:123]
    s_cmp_lt_i32 s58, -1
    v_mfma_f32_16x16x32_bf16 v[124:127], v[48:51], v[100:103], v[124:127]
    v_mfma_f32_16x16x32_bf16 v[128:131], v[52:55], v[100:103], v[128:131]
    s_waitcnt lgkmcnt(0)
    s_barrier
    v_mfma_f32_16x16x32_bf16 v[112:115], v[56:59], v[104:107], v[112:115]
    ds_read_b128 v[96:99], v12 offset:0
    ds_read_b128 v[16:19], v11 offset:0
    ds_read_b128 v[20:23], v11 offset:2048
    v_mfma_f32_16x16x32_bf16 v[116:119], v[60:63], v[104:107], v[116:119]
    ds_read_b128 v[24:27], v11 offset:4096
    ds_read_b128 v[28:31], v11 offset:6144
    ds_read_b128 v[32:35], v11 offset:8192
    v_mfma_f32_16x16x32_bf16 v[120:123], v[64:67], v[104:107], v[120:123]
    ds_read_b128 v[100:103], v12 offset:1024
    ds_read_b128 v[36:39], v11 offset:1024
    ds_read_b128 v[40:43], v11 offset:3072
    v_mfma_f32_16x16x32_bf16 v[124:127], v[68:71], v[104:107], v[124:127]
    ds_read_b128 v[44:47], v11 offset:5120
    ds_read_b128 v[48:51], v11 offset:7168
    ds_read_b128 v[52:55], v11 offset:9216
    v_mfma_f32_16x16x32_bf16 v[128:131], v[72:75], v[104:107], v[128:131]
    v_add_u32 v11, s57, v3
    v_add_u32 v12, s56, v10
    s_add_u32 s56, s56, 8192
    v_mfma_f32_16x16x32_bf16 v[112:115], v[76:79], v[108:111], v[112:115]
    s_cmp_ge_u32 s56, 49152
    s_cselect_b32 s56, 0, s56
    s_add_u32 s57, s57, 10240
    v_mfma_f32_16x16x32_bf16 v[116:119], v[80:83], v[108:111], v[116:119]
    s_cmp_ge_u32 s57, 163840
    s_cselect_b32 s57, 61440, s57
    s_sub_u32 s58, s58, 1
    v_mfma_f32_16x16x32_bf16 v[120:123], v[84:87], v[108:111], v[120:123]
    s_cmp_lt_i32 s58, -1
    v_mfma_f32_16x16x32_bf16 v[124:127], v[88:91], v[108:111], v[124:127]
    v_mfma_f32_16x16x32_bf16 v[128:131], v[92:95], v[108:111], v[128:131]
    s_cbranch_scc1 CB_X
    s_waitcnt lgkmcnt(0)
    s_barrier
    v_mfma_f32_16x16x32_bf16 v[112:115], v[16:19], v[96:99], v[112:115]
    ds_read_b128 v[104:107], v12 offset:0
    ds_read_b128 v[56:59], v11 offset:0
    ds_read_b128 v[60:63], v11 offset:2048
    v_mfma_f32_16x16x32_bf16 v[116:119], v[20:23], v[96:99], v[116:119]
    ds_read_b128 v[64:67], v11 offset:4096
    ds_read_b128 v[68:71], v11 offset:6144
    ds_read_b128 v[72:75], v11 offset:8192
    v_mfma_f32_16x16x32_bf16 v[120:123], v[24:27], v[96:99], v[120:123]
    ds_read_b128 v[108:111], v12 offset:1024
    ds_read_b128 v[76:79], v11 offset:1024
    ds_read_b128 v[80:83], v11 offset:3072
    v_mfma_f32_16x16x32_bf16 v[124:127], v[28:31], v[96:99], v[124:127]
    ds_read_b128 v[84:87], v11 offset:5120
    ds_read_b128 v[88:91], v11 offset:7168
    ds_read_b128 v[92:95], v11 offset:9216
    v_mfma_f32_16x16x32_bf16 v[128:131], v[32:35], v[96:99], v[128:131]
    v_add_u32 v11, s57, v3
    v_add_u32 v12, s56, v10
    s_add_u32 s56, s56, 8192
    v_mfma_f32_16x16x32_bf16 v[112:115], v[36:39], v[100:103], v[112:115]
    s_cmp_ge_u32 s56, 49152
    s_cselect_b32 s56, 0, s56
    s_add_u32 s57, s57, 10240
    v_mfma_f32_16x16x32_bf16 v[116:119], v[40:43], v[100:103], v[116:119]
    s_cmp_ge_u32 s57, 163840
    s_cselect_b32 s57, 61440, s57
    s_sub_u32 s58, s58, 1
    v_mfma_f32_16x16x32_bf16 v[120:123], v[44:47], v[100:103], v[120:123]
    s_cmp_lt_i32 s58, -1
    v_mfma_f32_16x16x32_bf16 v[124:127], v[48:51], v[100:103], v[124:127]
    v_mfma_f32_16x16x32_bf16 v[128:131], v[52:55], v[100:103], v[128:131]
    s_waitcnt lgkmcnt(0)
    s_barrier
    v_mfma_f32_16x16x32_bf16 v[112:115], v[56:59], v[104:107], v[112:115]
    ds_read_b128 v[96:99], v12 offset:0
    ds_read_b128 v[16:19], v11 offset:0
    ds_read_b128 v[20:23], v11 offset:2048
    v_mfma_f32_16x16x32_bf16 v[116:119], v[60:63], v[104:107], v[116:119]
    ds_read_b128 v[24:27], v11 offset:4096
    ds_read_b128 v[28:31], v11 offset:6144
    ds_read_b128 v[32:35], v11 offset:8192
    v_mfma_f32_16x16x32_bf16 v[120:123], v[64:67], v[104:107], v[120:123]
    ds_read_b128 v[100:103], v12 offset:1024
    ds_read_b128 v[36:39], v11 offset:1024
    ds_read_b128 v[40:43], v11 offset:3072
    v_mfma_f32_16x16x32_bf16 v[124:127], v[68:71], v[104:107], v[124:127]
    ds_read_b128 v[44:47], v11 offset:5120
    ds_read_b128 v[48:51], v11 offset:7168
    ds_read_b128 v[52:55], v11 offset:9216
    v_mfma_f32_16x16x32_bf16 v[128:131], v[72:75], v[104:107], v[128:131]
    v_add_u32 v11, s57, v3
    v_add_u32 v12, s56, v10
    s_add_u32 s56, s56, 8192
    v_mfma_f32_16x16x32_bf16 v[112:115], v[76:79], v[108:111], v[112:115]
    s_cmp_ge_u32 s56, 49152
    s_cselect_b32 s56, 0, s56
    s_add_u32 s57, s57, 10240
    v_mfma_f32_16x16x32_bf16 v[116:119], v[80:83], v[108:111], v[116:119]
    s_cmp_ge_u32 s57, 163840
    s_cselect_b32 s57, 61440, s57
    s_sub_u32 s58, s58, 1
    v_mfma_f32_16x16x32_bf16 v[120:123], v[84:87], v[108:111], v[120:123]
    s_cmp_ge_i32 s58, -1
    v_mfma_f32_16x16x32_bf16 v[124:127], v[88:91], v[108:111], v[124:127]
    v_mfma_f32_16x16x32_bf16 v[128:131], v[92:95], v[108:111], v[128:131]
    s_cbranch_scc1 CB_L
    s_nop 6
CB_X:
    s_nop 7
    s_waitcnt lgkmcnt(0)
    s_waitcnt vmcnt(0)
    v_lshlrev_b32 v48, 16, v200
    v_and_b32 v49, 0xffff0000, v200
    v_lshlrev_b32 v50, 16, v201
    v_and_b32 v51, 0xffff0000, v201
    v_lshlrev_b32 v52, 16, v202
    v_and_b32 v53, 0xffff0000, v202
    v_lshlrev_b32 v54, 16, v203
    v_and_b32 v55, 0xffff0000, v203
    v_lshlrev_b32 v56, 16, v204
    v_and_b32 v57, 0xffff0000, v204
    v_lshlrev_b32 v58, 16, v205
    v_and_b32 v59, 0xffff0000, v205
    v_lshlrev_b32 v60, 16, v206
    v_and_b32 v61, 0xffff0000, v206
    v_lshlrev_b32 v62, 16, v207
    v_and_b32 v63, 0xffff0000, v207
    v_lshlrev_b32 v64, 16, v208
    v_and_b32 v65, 0xffff0000, v208
    v_lshlrev_b32 v66, 16, v209
    v_and_b32 v67, 0xffff0000, v209
    v_pk_fma_f32 v[48:49], v[140:141], v[112:113], v[48:49]
    v_pk_fma_f32 v[50:51], v[142:143], v[114:115], v[50:51]
    v_pk_fma_f32 v[52:53], v[144:145], v[116:117], v[52:53]
    v_pk_fma_f32 v[54:55], v[146:147], v[118:119], v[54:55]
    v_pk_fma_f32 v[56:57], v[148:149], v[120:121], v[56:57]
    v_pk_fma_f32 v[58:59], v[150:151], v[122:123], v[58:59]
    v_pk_fma_f32 v[60:61], v[152:153], v[124:125], v[60:61]
    v_pk_fma_f32 v[62:63], v[154:155], v[126:127], v[62:63]
    v_pk_fma_f32 v[64:65], v[156:157], v[128:129], v[64:65]
    v_pk_fma_f32 v[66:67], v[158:159], v[130:131], v[66:67]
    v_cvt_pk_bf16_f32 v240, v48, v49
    v_cvt_pk_bf16_f32 v241, v50, v51
    v_cvt_pk_bf16_f32 v242, v52, v53
    v_cvt_pk_bf16_f32 v243, v54, v55
    v_cvt_pk_bf16_f32 v244, v56, v57
    v_cvt_pk_bf16_f32 v245, v58, v59
    v_cvt_pk_bf16_f32 v246, v60, v61
    v_cvt_pk_bf16_f32 v247, v62, v63
    v_cvt_pk_bf16_f32 v248, v64, v65
    v_cvt_pk_bf16_f32 v249, v66, v67
    v_lshlrev_b32 v48, 16, v240
    v_and_b32 v49, 0xffff0000, v240
    v_lshlrev_b32 v50, 16, v241
    v_and_b32 v51, 0xffff0000, v241
    v_lshlrev_b32 v52, 16, v242
    v_and_b32 v53, 0xffff0000, v242
    v_lshlrev_b32 v54, 16, v243
    v_and_b32 v55, 0xffff0000, v243
    v_lshlrev_b32 v56, 16, v244
    v_and_b32 v57, 0xffff0000, v244
    v_lshlrev_b32 v58, 16, v245
    v_and_b32 v59, 0xffff0000, v245
    v_lshlrev_b32 v60, 16, v246
    v_and_b32 v61, 0xffff0000, v246
    v_lshlrev_b32 v62, 16, v247
    v_and_b32 v63, 0xffff0000, v247
    v_lshlrev_b32 v64, 16, v248
    v_and_b32 v65, 0xffff0000, v248
    v_lshlrev_b32 v66, 16, v249
    v_and_b32 v67, 0xffff0000, v249
    v_pk_mul_f32 v[68:69], v[48:49], v[160:161]
    v_pk_mul_f32 v[70:71], v[50:51], v[162:163]
    v_pk_mul_f32 v[72:73], v[52:53], v[164:165]
    v_pk_mul_f32 v[74:75], v[54:55], v[166:167]
    v_pk_mul_f32 v[76:77], v[56:57], v[168:169]
    v_pk_mul_f32 v[78:79], v[58:59], v[170:171]
    v_pk_mul_f32 v[80:81], v[60:61], v[172:173]
    v_pk_mul_f32 v[82:83], v[62:63], v[174:175]
    v_pk_mul_f32 v[84:85], v[64:65], v[176:177]
    v_pk_mul_f32 v[86:87], v[66:67], v[178:179]
    v_pk_add_f32 v[16:17], v[48:49], v[50:51]
    v_pk_mul_f32 v[18:19], v[48:49], v[48:49]
    v_pk_add_f32 v[20:21], v[68:69], v[70:71]
    v_pk_mul_f32 v[22:23], v[68:69], v[68:69]
    v_pk_mul_f32 v[24:25], v[68:69], v[160:161]
    v_pk_mul_f32 v[26:27], v[68:69], v[180:181]
    v_pk_fma_f32 v[18:19], v[50:51], v[50:51], v[18:19]
    v_pk_fma_f32 v[22:23], v[70:71], v[70:71], v[22:23]
    v_pk_fma_f32 v[24:25], v[70:71], v[162:163], v[24:25]
    v_pk_fma_f32 v[26:27], v[70:71], v[182:183], v[26:27]
    v_pk_add_f32 v[16:17], v[16:17], v[52:53]
    v_pk_add_f32 v[20:21], v[20:21], v[72:73]
    v_pk_fma_f32 v[18:19], v[52:53], v[52:53], v[18:19]
    v_pk_fma_f32 v[22:23], v[72:73], v[72:73], v[22:23]
    v_pk_fma_f32 v[24:25], v[72:73], v[164:165], v[24:25]
    v_pk_fma_f32 v[26:27], v[72:73], v[184:185], v[26:27]
    v_pk_add_f32 v[16:17], v[16:17], v[54:55]
    v_pk_add_f32 v[20:21], v[20:21], v[74:75]
    v_pk_fma_f32 v[18:19], v[54:55], v[54:55], v[18:19]
    v_pk_fma_f32 v[22:23], v[74:75], v[74:75], v[22:23]
    v_pk_fma_f32 v[24:25], v[74:75], v[166:167], v[24:25]
    v_pk_fma_f32 v[26:27], v[74:75], v[186:187], v[26:27]
    v_pk_add_f32 v[16:17], v[16:17], v[56:57]
    v_pk_add_f32 v[20:21], v[20:21], v[76:77]
    v_pk_fma_f32 v[18:19], v[56:57], v[56:57], v[18:19]
    v_pk_fma_f32 v[22:23], v[76:77], v[76:77], v[22:23]
    v_pk_fma_f32 v[24:25], v[76:77], v[168:169], v[24:25]
    v_pk_fma_f32 v[26:27], v[76:77], v[188:189], v[26:27]
    v_pk_add_f32 v[16:17], v[16:17], v[58:59]
    v_pk_add_f32 v[20:21], v[20:21], v[78:79]
    v_pk_fma_f32 v[18:19], v[58:59], v[58:59], v[18:19]
    v_pk_fma_f32 v[22:23], v[78:79], v[78:79], v[22:23]
    v_pk_fma_f32 v[24:25], v[78:79], v[170:171], v[24:25]
    v_pk_fma_f32 v[26:27], v[78:79], v[190:191], v[26:27]
    v_pk_add_f32 v[16:17], v[16:17], v[60:61]
    v_pk_add_f32 v[20:21], v[20:21], v[80:81]
    v_pk_fma_f32 v[18:19], v[60:61], v[60:61], v[18:19]
    v_pk_fma_f32 v[22:23], v[80:81], v[80:81], v[22:23]
    v_pk_fma_f32 v[24:25], v[80:81], v[172:173], v[24:25]
    v_pk_fma_f32 v[26:27], v[80:81], v[192:193], v[26:27]
    v_pk_add_f32 v[16:17], v[16:17], v[62:63]
    v_pk_add_f32 v[20:21], v[20:21], v[82:83]
    v_pk_fma_f32 v[18:19], v[62:63], v[62:63], v[18:19]
    v_pk_fma_f32 v[22:23], v[82:83], v[82:83], v[22:23]
    v_pk_fma_f32 v[24:25], v[82:83], v[174:175], v[24:25]
    v_pk_fma_f32 v[26:27], v[82:83], v[194:195], v[26:27]
    v_pk_add_f32 v[16:17], v[16:17], v[64:65]
    v_pk_add_f32 v[20:21], v[20:21], v[84:85]
    v_pk_fma_f32 v[18:19], v[64:65], v[64:65], v[18:19]
    v_pk_fma_f32 v[22:23], v[84:85], v[84:85], v[22:23]
    v_pk_fma_f32 v[24:25], v[84:85], v[176:177], v[24:25]
    v_pk_fma_f32 v[26:27], v[84:85], v[196:197], v[26:27]
    v_pk_add_f32 v[16:17], v[16:17], v[66:67]
    v_pk_add_f32 v[20:21], v[20:21], v[86:87]
    v_pk_fma_f32 v[18:19], v[66:67], v[66:67], v[18:19]
    v_pk_fma_f32 v[22:23], v[86:87], v[86:87], v[22:23]
    v_pk_fma_f32 v[24:25], v[86:87], v[178:179], v[24:25]
    v_pk_fma_f32 v[26:27], v[86:87], v[198:199], v[26:27]
    v_add_f32 v132, v16, v17
    v_add_f32 v133, v18, v19
    v_add_f32 v134, v20, v21
    v_add_f32 v136, v22, v23
    v_add_f32 v137, v24, v25
    v_add_f32 v138, v26, v27
    v_mov_b32 v28, v132
    s_nop 1
    v_permlane16_swap_b32 v132, v28
    v_add_f32 v132, v132, v28
    v_mov_b32 v28, v132
    s_nop 1
    v_permlane32_swap_b32 v132, v28
    v_add_f32 v132, v132, v28
    v_mov_b32 v29, v133
    s_nop 1
    v_permlane16_swap_b32 v133, v29
    v_add_f32 v133, v133, v29
    v_mov_b32 v29, v133
    s_nop 1
    v_permlane32_swap_b32 v133, v29
    v_add_f32 v133, v133, v29
    v_mov_b32 v30, v134
    s_nop 1
    v_permlane16_swap_b32 v134, v30
    v_add_f32 v134, v134, v30
    v_mov_b32 v30, v134
    s_nop 1
    v_permlane32_swap_b32 v134, v30
    v_add_f32 v134, v134, v30
    v_mov_b32 v31, v136
    s_nop 1
    v_permlane16_swap_b32 v136, v31
    v_add_f32 v136, v136, v31
    v_mov_b32 v31, v136
    s_nop 1
    v_permlane32_swap_b32 v136, v31
    v_add_f32 v136, v136, v31
    v_mov_b32 v32, v137
    s_nop 1
    v_permlane16_swap_b32 v137, v32
    v_add_f32 v137, v137, v32
    v_mov_b32 v32, v137
    s_nop 1
    v_permlane32_swap_b32 v137, v32
    v_add_f32 v137, v137, v32
    v_mov_b32 v33, v138
    s_nop 1
    v_permlane16_swap_b32 v138, v33
    v_add_f32 v138, v138, v33
    v_mov_b32 v33, v138
    s_nop 1
    v_permlane32_swap_b32 v138, v33
    v_add_f32 v138, v138, v33
    v_cmp_eq_u32 vcc, 1, v6
    s_nop 1
    v_cndmask_b32 v16, v132, v136, vcc
    v_cndmask_b32 v17, v133, v137, vcc
    v_cndmask_b32 v18, v134, v138, vcc
    v_mov_b32 v19, 1.0
    v_and_b32 v14, 15, v1
    v_lshlrev_b32 v14, 5, v14
    v_add_u32 v15, v14, v8
    s_lshl_b32 s30, s24, 12
    s_add_u32 s30, s30, 29360128
    s_lshl_b32 s34, s21, 9
    s_add_u32 s34, s34, s30
    s_mov_b32 exec_hi, 0
    s_cmp_lg_u32 s91, 0
    s_cbranch_scc1 XS_9
    buffer_store_dwordx4 v[16:19], v15, s[12:15], s34 offen sc1
    s_branch XS_10
XS_9:
    buffer_store_dwordx4 v[16:19], v15, s[12:15], s34 offen
XS_10:
    s_mov_b64 exec, -1
    v_lshl_add_u32 v14, v6, 10, v14
    s_mov_b32 s31, 0
M_GATHER:
    buffer_load_dwordx4 v[24:27], v14, s[12:15], s30 offen offset:0 sc1
    buffer_load_dwordx4 v[28:31], v14, s[12:15], s30 offen offset:16 sc1
    buffer_load_dwordx4 v[32:35], v14, s[12:15], s30 offen offset:512 sc1
    buffer_load_dwordx4 v[36:39], v14, s[12:15], s30 offen offset:528 sc1
    s_add_u32 s31, s31, 1
    s_waitcnt vmcnt(0)
    v_min_u32 v15, v27, v31
    v_min_u32 v13, v35, v39
    v_min_u32 v15, v15, v13
    v_cmp_eq_u32 vcc, 0, v15
    s_cmp_gt_u32 s31, 200000
    s_cselect_b64 s[32:33], 0, vcc
    s_cmp_lg_u64 s[32:33], 0
    s_cbranch_scc1 M_GATHER
    v_add_f32 v132, v24, v32
    v_add_f32 v136, v28, v36
    v_add_f32 v133, v25, v33
    v_add_f32 v137, v29, v37
    v_add_f32 v134, v26, v34
    v_add_f32 v138, v30, v38
    v_mov_b32 v16, v132
    s_nop 1
    v_permlane16_swap_b32 v132, v16
    v_add_f32 v132, v132, v16
    v_mov_b32 v16, v132
    s_nop 1
    v_permlane32_swap_b32 v132, v16
    v_add_f32 v132, v132, v16
    v_mov_b32 v17, v133
    s_nop 1
    v_permlane16_swap_b32 v133, v17
    v_add_f32 v133, v133, v17
    v_mov_b32 v17, v133
    s_nop 1
    v_permlane32_swap_b32 v133, v17
    v_add_f32 v133, v133, v17
    v_mov_b32 v18, v134
    s_nop 1
    v_permlane16_swap_b32 v134, v18
    v_add_f32 v134, v134, v18
    v_mov_b32 v18, v134
    s_nop 1
    v_permlane32_swap_b32 v134, v18
    v_add_f32 v134, v134, v18
    v_mov_b32 v19, v136
    s_nop 1
    v_permlane16_swap_b32 v136, v19
    v_add_f32 v136, v136, v19
    v_mov_b32 v19, v136
    s_nop 1
    v_permlane32_swap_b32 v136, v19
    v_add_f32 v136, v136, v19
    v_mov_b32 v20, v137
    s_nop 1
    v_permlane16_swap_b32 v137, v20
    v_add_f32 v137, v137, v20
    v_mov_b32 v20, v137
    s_nop 1
    v_permlane32_swap_b32 v137, v20
    v_add_f32 v137, v137, v20
    v_mov_b32 v21, v138
    s_nop 1
    v_permlane16_swap_b32 v138, v21
    v_add_f32 v138, v138, v21
    v_mov_b32 v21, v138
    s_nop 1
    v_permlane32_swap_b32 v138, v21
    v_add_f32 v138, v138, v21
    v_mul_f32 v132, 0x3acccccd, v132
    v_mul_f32 v133, 0x3acccccd, v133
    v_fma_f32 v133, -v132, v132, v133
    v_max_f32 v133, 0, v133
    v_cvt_pk_bf16_f32 v17, v133, v132
    v_and_b32 v16, 0xffff0000, v17
    v_lshlrev_b32 v17, 16, v17
    v_add_f32 v17, 0x3727c5ac, v17
    v_cvt_pk_bf16_f32 v17, v17, v17
    v_and_b32 v17, 0xffff0000, v17
    v_sqrt_f32 v17, v17
    s_nop 0
    v_cvt_pk_bf16_f32 v17, v17, v17
    v_and_b32 v17, 0xffff0000, v17
    v_rcp_f32 v17, v17
    v_fma_f32 v134, -v16, v212, v134
    v_fma_f32 v134, v134, v17, v215
    v_mul_f32 v18, v16, v213
    v_fma_f32 v18, -2.0, v137, v18
    v_fma_f32 v136, v16, v18, v136
    v_fma_f32 v138, -v16, v214, v138
    v_add_f32 v138, v138, v138
    v_fma_f32 v136, v136, v17, v138
    v_fma_f32 v136, v136, v17, v216
    v_mul_f32 v134, 0x3acccccd, v134
    v_mul_f32 v136, 0x3acccccd, v136
    v_fma_f32 v136, -v134, v134, v136
    v_max_f32 v136, 0, v136
    v_cvt_pk_bf16_f32 v21, v136, v134
    v_and_b32 v20, 0xffff0000, v21
    v_lshlrev_b32 v21, 16, v21
    v_add_f32 v21, 0x3727c5ac, v21
    v_cvt_pk_bf16_f32 v21, v21, v21
    v_and_b32 v21, 0xffff0000, v21
    v_sqrt_f32 v21, v21
    s_nop 0
    v_cvt_pk_bf16_f32 v21, v21, v21
    v_and_b32 v21, 0xffff0000, v21
    v_rcp_f32 v21, v21
    s_nop 0
    v_mul_f32 v24, v17, v21
    v_mul_f32 v26, -v16, v24
    v_mul_f32 v30, -v20, v21
    v_mov_b32 v28, v21
    v_mov_b32 v25, v24
    v_mov_b32 v27, v26
    v_mov_b32 v31, v30
    v_mov_b32 v29, v21
    v_pk_fma_f32 v[48:49], v[68:69], v[24:25], v[30:31]
    v_pk_fma_f32 v[50:51], v[70:71], v[24:25], v[30:31]
    v_pk_fma_f32 v[52:53], v[72:73], v[24:25], v[30:31]
    v_pk_fma_f32 v[54:55], v[74:75], v[24:25], v[30:31]
    v_pk_fma_f32 v[56:57], v[76:77], v[24:25], v[30:31]
    v_pk_fma_f32 v[58:59], v[78:79], v[24:25], v[30:31]
    v_pk_fma_f32 v[60:61], v[80:81], v[24:25], v[30:31]
    v_pk_fma_f32 v[62:63], v[82:83], v[24:25], v[30:31]
    v_pk_fma_f32 v[64:65], v[84:85], v[24:25], v[30:31]
    v_pk_fma_f32 v[66:67], v[86:87], v[24:25], v[30:31]
    v_pk_fma_f32 v[48:49], v[160:161], v[26:27], v[48:49]
    v_pk_fma_f32 v[50:51], v[162:163], v[26:27], v[50:51]
    v_pk_fma_f32 v[52:53], v[164:165], v[26:27], v[52:53]
    v_pk_fma_f32 v[54:55], v[166:167], v[26:27], v[54:55]
    v_pk_fma_f32 v[56:57], v[168:169], v[26:27], v[56:57]
    v_pk_fma_f32 v[58:59], v[170:171], v[26:27], v[58:59]
    v_pk_fma_f32 v[60:61], v[172:173], v[26:27], v[60:61]
    v_pk_fma_f32 v[62:63], v[174:175], v[26:27], v[62:63]
    v_pk_fma_f32 v[64:65], v[176:177], v[26:27], v[64:65]
    v_pk_fma_f32 v[66:67], v[178:179], v[26:27], v[66:67]
    v_pk_fma_f32 v[48:49], v[180:181], v[28:29], v[48:49]
    v_pk_fma_f32 v[50:51], v[182:183], v[28:29], v[50:51]
    v_pk_fma_f32 v[52:53], v[184:185], v[28:29], v[52:53]
    v_pk_fma_f32 v[54:55], v[186:187], v[28:29], v[54:55]
    v_pk_fma_f32 v[56:57], v[188:189], v[28:29], v[56:57]
    v_pk_fma_f32 v[58:59], v[190:191], v[28:29], v[58:59]
    v_pk_fma_f32 v[60:61], v[192:193], v[28:29], v[60:61]
    v_pk_fma_f32 v[62:63], v[194:195], v[28:29], v[62:63]
    v_pk_fma_f32 v[64:65], v[196:197], v[28:29], v[64:65]
    v_pk_fma_f32 v[66:67], v[198:199], v[28:29], v[66:67]
    v_cvt_pk_bf16_f32 v200, v48, v49
    v_cvt_pk_bf16_f32 v201, v50, v51
    v_cvt_pk_bf16_f32 v202, v52, v53
    v_cvt_pk_bf16_f32 v203, v54, v55
    v_cvt_pk_bf16_f32 v204, v56, v57
    v_cvt_pk_bf16_f32 v205, v58, v59
    v_cvt_pk_bf16_f32 v206, v60, v61
    v_cvt_pk_bf16_f32 v207, v62, v63
    v_cvt_pk_bf16_f32 v208, v64, v65
    v_cvt_pk_bf16_f32 v209, v66, v67
    s_mul_i32 s30, s24, 20480
    s_add_u32 s30, s30, 18874368
    s_lshl_b32 s31, s21, 11
    s_add_u32 s31, s31, s30
    s_lshl_b32 s34, s21, 9
    s_add_u32 s34, s34, s30
    s_add_u32 s34, s34, 16384
    v_lshlrev_b32 v14, 3, v1
    s_cmp_lg_u32 s91, 0
    s_cbranch_scc1 XS_11
    buffer_store_dwordx4 v[200:203], v3, s[12:15], s31 offen sc1
    buffer_store_dwordx4 v[204:207], v3, s[12:15], s31 offen offset:1024 sc1
    buffer_store_dwordx2 v[208:209], v14, s[12:15], s34 offen sc1
    s_branch XS_12
XS_11:
    buffer_store_dwordx4 v[200:203], v3, s[12:15], s31 offen
    buffer_store_dwordx4 v[204:207], v3, s[12:15], s31 offen offset:1024
    buffer_store_dwordx2 v[208:209], v14, s[12:15], s34 offen
XS_12:
    s_lshl_b32 s30, s24, 3
    s_add_u32 s30, s30, s21
    s_lshl_b32 s30, s30, 7
    s_add_u32 s30, s30, 786432
    v_mov_b32 v16, 1
    v_mov_b32 v17, 0
    s_waitcnt vmcnt(0)
    s_mov_b64 exec, 1
    s_cmp_lg_u32 s91, 0
    s_cbranch_scc1 XS_13
    buffer_store_dword v16, v17, s[12:15], s30 offen sc1
    s_branch XS_14
XS_13:
    buffer_store_dword v16, v17, s[12:15], s30 offen
XS_14:
    s_nop 0
    s_mov_b64 exec, -1
    s_barrier
    s_lshl_b32 s43, s22, 3
    s_lshl_b32 s25, s3, 1
    s_add_u32 s43, s43, s25
    s_lshl_b32 s44, s23, 5
    s_lshl_b32 s26, s3, 12
    v_add_u32 v10, s26, v3
    v_add_u32 v11, s26, v4
    v_add_u32 v13, 2048, v10
    v_add_u32 v14, 2048, v11
    v_lshlrev_b32 v24, 3, v1
    v_add_u32 v24, s26, v24
    v_add_u32 v25, 61440, v24
    v_add_u32 v26, 2048, v24
    v_add_u32 v27, 2048, v25
    s_mul_i32 s30, s43, 55296
    s_mul_i32 s31, s29, 3072
    s_add_u32 s30, s30, s31
    s_add_u32 s30, s30, 22020096
    v_and_b32 v22, 31, v1
    v_lshlrev_b32 v22, 7, v22
    v_lshrrev_b32 v23, 5, v1
    v_mul_u32_u24 v23, 55296, v23
    v_add_u32 v22, v22, v23
    s_mov_b32 exec_lo, 0xffffff
    s_mov_b32 exec_hi, 0xffffff
    buffer_load_dword v23, v22, s[12:15], s30 offen
    s_mov_b64 exec, -1
    v_lshlrev_b32 v32, 16, v218
    v_and_b32 v33, 0xffff0000, v218
    v_lshlrev_b32 v34, 16, v219
    v_and_b32 v35, 0xffff0000, v219
    v_lshlrev_b32 v60, 16, v218
    v_and_b32 v61, 0xffff0000, v218
    v_lshlrev_b32 v62, 16, v219
    v_and_b32 v63, 0xffff0000, v219
    v_lshlrev_b32 v36, 16, v220
    v_and_b32 v37, 0xffff0000, v220
    v_lshlrev_b32 v38, 16, v221
    v_and_b32 v39, 0xffff0000, v221
    v_lshlrev_b32 v64, 16, v220
    v_and_b32 v65, 0xffff0000, v220
    v_lshlrev_b32 v66, 16, v221
    v_and_b32 v67, 0xffff0000, v221
    v_lshlrev_b32 v40, 16, v222
    v_and_b32 v41, 0xffff0000, v222
    v_lshlrev_b32 v42, 16, v223
    v_and_b32 v43, 0xffff0000, v223
    v_lshlrev_b32 v68, 16, v222
    v_and_b32 v69, 0xffff0000, v222
    v_lshlrev_b32 v70, 16, v223
    v_and_b32 v71, 0xffff0000, v223
    v_lshlrev_b32 v44, 16, v224
    v_and_b32 v45, 0xffff0000, v224
    v_lshlrev_b32 v46, 16, v225
    v_and_b32 v47, 0xffff0000, v225
    v_lshlrev_b32 v72, 16, v224
    v_and_b32 v73, 0xffff0000, v224
    v_lshlrev_b32 v74, 16, v225
    v_and_b32 v75, 0xffff0000, v225
    v_lshlrev_b32 v48, 16, v226
    v_and_b32 v49, 0xffff0000, v226
    v_lshlrev_b32 v50, 16, v227
    v_and_b32 v51, 0xffff0000, v227
    v_lshlrev_b32 v76, 16, v226
    v_and_b32 v77, 0xffff0000, v226
    v_lshlrev_b32 v78, 16, v227
    v_and_b32 v79, 0xffff0000, v227
    v_lshlrev_b32 v52, 16, v228
    v_and_b32 v53, 0xffff0000, v228
    v_lshlrev_b32 v54, 16, v229
    v_and_b32 v55, 0xffff0000, v229
    v_lshlrev_b32 v80, 16, v228
    v_and_b32 v81, 0xffff0000, v228
    v_lshlrev_b32 v82, 16, v229
    v_and_b32 v83, 0xffff0000, v229
    v_lshlrev_b32 v56, 16, v230
    v_and_b32 v57, 0xffff0000, v230
    v_lshlrev_b32 v58, 16, v231
    v_and_b32 v59, 0xffff0000, v231
    v_lshlrev_b32 v84, 16, v230
    v_and_b32 v85, 0xffff0000, v230
    v_lshlrev_b32 v86, 16, v231
    v_and_b32 v87, 0xffff0000, v231
    s_mov_b32 s16, s96
    s_and_b32 s17, s97, 0xffff
    s_mov_b32 s18, 1280
    s_mov_b32 s19, 0x00020000
    buffer_load_dwordx2 v[204:205], v7, s[16:19], s28 offen offset:0
    buffer_load_dwordx2 v[206:207], v7, s[16:19], s28 offen offset:32
    buffer_load_dwordx2 v[208:209], v7, s[16:19], s28 offen offset:64
    buffer_load_dwordx2 v[210:211], v7, s[16:19], s28 offen offset:96
    buffer_load_dwordx2 v[212:213], v7, s[16:19], s28 offen offset:128
    s_lshl_b32 s30, s28, 1
    s_add_u32 s30, s30, 73216
    buffer_load_dwordx4 v[214:217], v8, s[12:15], s30 offen offset:0 sc1
    buffer_load_dwordx4 v[218:221], v8, s[12:15], s30 offen offset:64 sc1
    buffer_load_dwordx4 v[222:225], v8, s[12:15], s30 offen offset:128 sc1
    buffer_load_dwordx4 v[226:229], v8, s[12:15], s30 offen offset:192 sc1
    buffer_load_dwordx4 v[230:233], v8, s[12:15], s30 offen offset:256 sc1
    s_mov_b32 s56, 0
    s_mov_b32 s57, 65536
    s_mov_b32 s58, 10
    v_add_u32 v11, s57, v3
    s_cmp_le_u32 s58, 2
    s_cselect_b64 vcc, -1, 0
    s_cselect_b32 s59, 512, 8
    v_cndmask_b32 v12, v10, v24, vcc
    v_add_u32 v12, s56, v12
    v_add_u32 v14, s59, v12
    v_cndmask_b32 v25, v13, v26, vcc
    v_add_u32 v25, s56, v25
    v_add_u32 v27, s59, v25
    s_add_u32 s56, s56, 16384
    s_cmp_ge_u32 s56, 65536
    s_cselect_b32 s56, 0, s56
    s_add_u32 s57, s57, 14336
    s_cmp_ge_u32 s57, 151552
    s_cselect_b32 s57, 65536, s57
    s_sub_u32 s58, s58, 1
    s_waitcnt lgkmcnt(0)
    s_barrier
    ds_read_b64 v[188:189], v12 offset:0
    ds_read_b64 v[190:191], v14 offset:0
    ds_read_b64 v[192:193], v25 offset:0
    ds_read_b64 v[194:195], v27 offset:0
    ds_read_b128 v[88:91], v11 offset:0
    ds_read_b128 v[92:95], v11 offset:2048
    ds_read_b128 v[96:99], v11 offset:4096
    ds_read_b128 v[100:103], v11 offset:6144
    ds_read_b128 v[104:107], v11 offset:8192
    ds_read_b128 v[108:111], v11 offset:10240
    ds_read_b128 v[112:115], v11 offset:12288
C3_L:
    s_waitcnt lgkmcnt(0)
    v_mfma_f32_16x16x32_bf16 v[32:35], v[88:91], v[188:191], v[32:35]
    ds_read_b64 v[196:197], v12 offset:1024
    ds_read_b64 v[198:199], v14 offset:1024
    v_mfma_f32_16x16x32_bf16 v[60:63], v[88:91], v[192:195], v[60:63]
    ds_read_b64 v[200:201], v25 offset:1024
    ds_read_b64 v[202:203], v27 offset:1024
    v_mfma_f32_16x16x32_bf16 v[36:39], v[92:95], v[188:191], v[36:39]
    ds_read_b128 v[116:119], v11 offset:1024
    ds_read_b128 v[120:123], v11 offset:3072
    v_mfma_f32_16x16x32_bf16 v[64:67], v[92:95], v[192:195], v[64:67]
    ds_read_b128 v[124:127], v11 offset:5120
    ds_read_b128 v[128:131], v11 offset:7168
    v_mfma_f32_16x16x32_bf16 v[40:43], v[96:99], v[188:191], v[40:43]
    ds_read_b128 v[132:135], v11 offset:9216
    ds_read_b128 v[136:139], v11 offset:11264
    v_mfma_f32_16x16x32_bf16 v[68:71], v[96:99], v[192:195], v[68:71]
    ds_read_b128 v[140:143], v11 offset:13312
    v_add_u32 v11, s57, v3
    v_mfma_f32_16x16x32_bf16 v[44:47], v[100:103], v[188:191], v[44:47]
    s_cmp_le_u32 s58, 2
    s_cselect_b64 vcc, -1, 0
    v_mfma_f32_16x16x32_bf16 v[72:75], v[100:103], v[192:195], v[72:75]
    s_cselect_b32 s59, 512, 8
    v_cndmask_b32 v12, v10, v24, vcc
    v_mfma_f32_16x16x32_bf16 v[48:51], v[104:107], v[188:191], v[48:51]
    v_add_u32 v12, s56, v12
    v_add_u32 v14, s59, v12
    v_mfma_f32_16x16x32_bf16 v[76:79], v[104:107], v[192:195], v[76:79]
    v_cndmask_b32 v25, v13, v26, vcc
    v_add_u32 v25, s56, v25
    v_mfma_f32_16x16x32_bf16 v[52:55], v[108:111], v[188:191], v[52:55]
    v_add_u32 v27, s59, v25
    s_add_u32 s56, s56, 16384
    v_mfma_f32_16x16x32_bf16 v[80:83], v[108:111], v[192:195], v[80:83]
    s_cmp_ge_u32 s56, 65536
    s_cselect_b32 s56, 0, s56
    v_mfma_f32_16x16x32_bf16 v[56:59], v[112:115], v[188:191], v[56:59]
    s_add_u32 s57, s57, 14336
    s_cmp_ge_u32 s57, 151552
    v_mfma_f32_16x16x32_bf16 v[84:87], v[112:115], v[192:195], v[84:87]
    s_cselect_b32 s57, 65536, s57
    s_sub_u32 s58, s58, 1
    s_waitcnt lgkmcnt(0)
    s_barrier
    v_mfma_f32_16x16x32_bf16 v[32:35], v[116:119], v[196:199], v[32:35]
    ds_read_b64 v[188:189], v12 offset:0
    ds_read_b64 v[190:191], v14 offset:0
    v_mfma_f32_16x16x32_bf16 v[60:63], v[116:119], v[200:203], v[60:63]
    ds_read_b64 v[192:193], v25 offset:0
    ds_read_b64 v[194:195], v27 offset:0
    v_mfma_f32_16x16x32_bf16 v[36:39], v[120:123], v[196:199], v[36:39]
    ds_read_b128 v[88:91], v11 offset:0
    ds_read_b128 v[92:95], v11 offset:2048
    v_mfma_f32_16x16x32_bf16 v[64:67], v[120:123], v[200:203], v[64:67]
    ds_read_b128 v[96:99], v11 offset:4096
    ds_read_b128 v[100:103], v11 offset:6144
    v_mfma_f32_16x16x32_bf16 v[40:43], v[124:127], v[196:199], v[40:43]
    ds_read_b128 v[104:107], v11 offset:8192
    ds_read_b128 v[108:111], v11 offset:10240
    v_mfma_f32_16x16x32_bf16 v[68:71], v[124:127], v[200:203], v[68:71]
    ds_read_b128 v[112:115], v11 offset:12288
    s_cmp_ge_i32 s58, 0
    v_mfma_f32_16x16x32_bf16 v[44:47], v[128:131], v[196:199], v[44:47]
    v_mfma_f32_16x16x32_bf16 v[72:75], v[128:131], v[200:203], v[72:75]
    v_mfma_f32_16x16x32_bf16 v[48:51], v[132:135], v[196:199], v[48:51]
    v_mfma_f32_16x16x32_bf16 v[76:79], v[132:135], v[200:203], v[76:79]
    v_mfma_f32_16x16x32_bf16 v[52:55], v[136:139], v[196:199], v[52:55]
    v_mfma_f32_16x16x32_bf16 v[80:83], v[136:139], v[200:203], v[80:83]
    v_mfma_f32_16x16x32_bf16 v[56:59], v[140:143], v[196:199], v[56:59]
    v_mfma_f32_16x16x32_bf16 v[84:87], v[140:143], v[200:203], v[84:87]
    s_waitcnt lgkmcnt(0)
    v_mfma_f32_16x16x32_bf16 v[32:35], v[88:91], v[188:191], v[32:35]
    ds_read_b64 v[196:197], v12 offset:1024
    ds_read_b64 v[198:199], v14 offset:1024
    v_mfma_f32_16x16x32_bf16 v[60:63], v[88:91], v[192:195], v[60:63]
    ds_read_b64 v[200:201], v25 offset:1024
    ds_read_b64 v[202:203], v27 offset:1024
    v_mfma_f32_16x16x32_bf16 v[36:39], v[92:95], v[188:191], v[36:39]
    ds_read_b128 v[116:119], v11 offset:1024
    ds_read_b128 v[120:123], v11 offset:3072
    v_mfma_f32_16x16x32_bf16 v[64:67], v[92:95], v[192:195], v[64:67]
    ds_read_b128 v[124:127], v11 offset:5120
    ds_read_b128 v[128:131], v11 offset:7168
    v_mfma_f32_16x16x32_bf16 v[40:43], v[96:99], v[188:191], v[40:43]
    ds_read_b128 v[132:135], v11 offset:9216
    ds_read_b128 v[136:139], v11 offset:11264
    v_mfma_f32_16x16x32_bf16 v[68:71], v[96:99], v[192:195], v[68:71]
    ds_read_b128 v[140:143], v11 offset:13312
    v_add_u32 v11, s57, v3
    v_mfma_f32_16x16x32_bf16 v[44:47], v[100:103], v[188:191], v[44:47]
    s_cmp_le_u32 s58, 2
    s_cselect_b64 vcc, -1, 0
    v_mfma_f32_16x16x32_bf16 v[72:75], v[100:103], v[192:195], v[72:75]
    s_cselect_b32 s59, 512, 8
    v_cndmask_b32 v12, v10, v24, vcc
    v_mfma_f32_16x16x32_bf16 v[48:51], v[104:107], v[188:191], v[48:51]
    v_add_u32 v12, s56, v12
    v_add_u32 v14, s59, v12
    v_mfma_f32_16x16x32_bf16 v[76:79], v[104:107], v[192:195], v[76:79]
    v_cndmask_b32 v25, v13, v26, vcc
    v_add_u32 v25, s56, v25
    v_mfma_f32_16x16x32_bf16 v[52:55], v[108:111], v[188:191], v[52:55]
    v_add_u32 v27, s59, v25
    s_add_u32 s56, s56, 16384
    v_mfma_f32_16x16x32_bf16 v[80:83], v[108:111], v[192:195], v[80:83]
    s_cmp_ge_u32 s56, 65536
    s_cselect_b32 s56, 0, s56
    v_mfma_f32_16x16x32_bf16 v[56:59], v[112:115], v[188:191], v[56:59]
    s_add_u32 s57, s57, 14336
    s_cmp_ge_u32 s57, 151552
    v_mfma_f32_16x16x32_bf16 v[84:87], v[112:115], v[192:195], v[84:87]
    s_cselect_b32 s57, 65536, s57
    s_sub_u32 s58, s58, 1
    s_waitcnt lgkmcnt(0)
    s_barrier
    v_mfma_f32_16x16x32_bf16 v[32:35], v[116:119], v[196:199], v[32:35]
    ds_read_b64 v[188:189], v12 offset:0
    ds_read_b64 v[190:191], v14 offset:0
    v_mfma_f32_16x16x32_bf16 v[60:63], v[116:119], v[200:203], v[60:63]
    ds_read_b64 v[192:193], v25 offset:0
    ds_read_b64 v[194:195], v27 offset:0
    v_mfma_f32_16x16x32_bf16 v[36:39], v[120:123], v[196:199], v[36:39]
    ds_read_b128 v[88:91], v11 offset:0
    ds_read_b128 v[92:95], v11 offset:2048
    v_mfma_f32_16x16x32_bf16 v[64:67], v[120:123], v[200:203], v[64:67]
    ds_read_b128 v[96:99], v11 offset:4096
    ds_read_b128 v[100:103], v11 offset:6144
    v_mfma_f32_16x16x32_bf16 v[40:43], v[124:127], v[196:199], v[40:43]
    ds_read_b128 v[104:107], v11 offset:8192
    ds_read_b128 v[108:111], v11 offset:10240
    v_mfma_f32_16x16x32_bf16 v[68:71], v[124:127], v[200:203], v[68:71]
    ds_read_b128 v[112:115], v11 offset:12288
    s_cmp_ge_i32 s58, 0
    v_mfma_f32_16x16x32_bf16 v[44:47], v[128:131], v[196:199], v[44:47]
    v_mfma_f32_16x16x32_bf16 v[72:75], v[128:131], v[200:203], v[72:75]
    v_mfma_f32_16x16x32_bf16 v[48:51], v[132:135], v[196:199], v[48:51]
    v_mfma_f32_16x16x32_bf16 v[76:79], v[132:135], v[200:203], v[76:79]
    v_mfma_f32_16x16x32_bf16 v[52:55], v[136:139], v[196:199], v[52:55]
    v_mfma_f32_16x16x32_bf16 v[80:83], v[136:139], v[200:203], v[80:83]
    v_mfma_f32_16x16x32_bf16 v[56:59], v[140:143], v[196:199], v[56:59]
    v_mfma_f32_16x16x32_bf16 v[84:87], v[140:143], v[200:203], v[84:87]
    s_cbranch_scc1 C3_L
    s_waitcnt lgkmcnt(0)
    v_mov_b32 v16, 0xc0135761
    v_mov_b32 v17, 0xc0135761
    v_mov_b32 v18, 0xbdd2d3e8
    v_mov_b32 v19, 0xbdd2d3e8
    v_mov_b32 v20, 1.0
    v_mov_b32 v21, 1.0
    s_mul_i32 s31, s43, 55296
    s_add_u32 s31, s31, 22020096
    s_mul_i32 s33, s29, 3072
    s_add_u32 s33, s33, s31
    s_add_u32 s35, s33, 55296
    s_lshr_b32 s32, s29, 2
    s_sub_u32 s32, s29, s32
    s_sub_u32 s32, s32, 1
    s_and_b32 s34, s32, 1
    s_mul_i32 s34, s34, 55296
    s_lshr_b32 s32, s32, 1
    s_lshl_b32 s32, s32, 10
    s_add_u32 s34, s34, s32
    s_add_u32 s34, s34, s31
    s_add_u32 s34, s34, 49152
    v_pk_mul_f32 v[172:173], v[32:33], v[32:33]
    v_pk_mul_f32 v[174:175], v[34:35], v[34:35]
    v_pk_mul_f32 v[176:177], v[60:61], v[60:61]
    v_pk_mul_f32 v[178:179], v[62:63], v[62:63]
    v_pk_fma_f32 v[172:173], v[172:173], v[18:19], v[16:17]
    v_pk_fma_f32 v[174:175], v[174:175], v[18:19], v[16:17]
    v_pk_fma_f32 v[176:177], v[176:177], v[18:19], v[16:17]
    v_pk_fma_f32 v[178:179], v[178:179], v[18:19], v[16:17]
    v_pk_mul_f32 v[172:173], v[172:173], v[32:33]
    v_pk_mul_f32 v[174:175], v[174:175], v[34:35]
    v_pk_mul_f32 v[176:177], v[176:177], v[60:61]
    v_pk_mul_f32 v[178:179], v[178:179], v[62:63]
    v_exp_f32 v172, v172
    v_exp_f32 v173, v173
    v_exp_f32 v174, v174
    v_exp_f32 v175, v175
    v_exp_f32 v176, v176
    v_exp_f32 v177, v177
    v_exp_f32 v178, v178
    v_exp_f32 v179, v179
    v_pk_add_f32 v[172:173], v[172:173], v[20:21]
    v_pk_add_f32 v[174:175], v[174:175], v[20:21]
    v_pk_add_f32 v[176:177], v[176:177], v[20:21]
    v_pk_add_f32 v[178:179], v[178:179], v[20:21]
    v_rcp_f32 v172, v172
    v_rcp_f32 v173, v173
    v_rcp_f32 v174, v174
    v_rcp_f32 v175, v175
    v_rcp_f32 v176, v176
    v_rcp_f32 v177, v177
    v_rcp_f32 v178, v178
    v_rcp_f32 v179, v179
    v_pk_mul_f32 v[32:33], v[32:33], v[172:173]
    v_pk_mul_f32 v[34:35], v[34:35], v[174:175]
    v_pk_mul_f32 v[60:61], v[60:61], v[176:177]
    v_pk_mul_f32 v[62:63], v[62:63], v[178:179]
    v_cvt_pk_bf16_f32 v88, v32, v33
    v_cvt_pk_bf16_f32 v89, v34, v35
    v_cvt_pk_bf16_f32 v92, v60, v61
    v_cvt_pk_bf16_f32 v93, v62, v63
    v_pk_mul_f32 v[172:173], v[36:37], v[36:37]
    v_pk_mul_f32 v[174:175], v[38:39], v[38:39]
    v_pk_mul_f32 v[176:177], v[64:65], v[64:65]
    v_pk_mul_f32 v[178:179], v[66:67], v[66:67]
    v_pk_fma_f32 v[172:173], v[172:173], v[18:19], v[16:17]
    v_pk_fma_f32 v[174:175], v[174:175], v[18:19], v[16:17]
    v_pk_fma_f32 v[176:177], v[176:177], v[18:19], v[16:17]
    v_pk_fma_f32 v[178:179], v[178:179], v[18:19], v[16:17]
    v_pk_mul_f32 v[172:173], v[172:173], v[36:37]
    v_pk_mul_f32 v[174:175], v[174:175], v[38:39]
    v_pk_mul_f32 v[176:177], v[176:177], v[64:65]
    v_pk_mul_f32 v[178:179], v[178:179], v[66:67]
    v_exp_f32 v172, v172
    v_exp_f32 v173, v173
    v_exp_f32 v174, v174
    v_exp_f32 v175, v175
    v_exp_f32 v176, v176
    v_exp_f32 v177, v177
    v_exp_f32 v178, v178
    v_exp_f32 v179, v179
    v_pk_add_f32 v[172:173], v[172:173], v[20:21]
    v_pk_add_f32 v[174:175], v[174:175], v[20:21]
    v_pk_add_f32 v[176:177], v[176:177], v[20:21]
    v_pk_add_f32 v[178:179], v[178:179], v[20:21]
    v_rcp_f32 v172, v172
    v_rcp_f32 v173, v173
    v_rcp_f32 v174, v174
    v_rcp_f32 v175, v175
    v_rcp_f32 v176, v176
    v_rcp_f32 v177, v177
    v_rcp_f32 v178, v178
    v_rcp_f32 v179, v179
    v_pk_mul_f32 v[36:37], v[36:37], v[172:173]
    v_pk_mul_f32 v[38:39], v[38:39], v[174:175]
    v_pk_mul_f32 v[64:65], v[64:65], v[176:177]
    v_pk_mul_f32 v[66:67], v[66:67], v[178:179]
    v_cvt_pk_bf16_f32 v90, v36, v37
    v_cvt_pk_bf16_f32 v91, v38, v39
    v_cvt_pk_bf16_f32 v94, v64, v65
    v_cvt_pk_bf16_f32 v95, v66, v67
    s_cmp_lg_u32 s91, 0
    s_cbranch_scc1 XS_15
    buffer_store_dwordx4 v[88:91], v3, s[12:15], s33 offen offset:0 sc1
    buffer_store_dwordx4 v[92:95], v3, s[12:15], s35 offen offset:0 sc1
    s_branch XS_16
XS_15:
    buffer_store_dwordx4 v[88:91], v3, s[12:15], s33 offen offset:0
    buffer_store_dwordx4 v[92:95], v3, s[12:15], s35 offen offset:0
XS_16:
    v_pk_mul_f32 v[172:173], v[40:41], v[40:41]
    v_pk_mul_f32 v[174:175], v[42:43], v[42:43]
    v_pk_mul_f32 v[176:177], v[68:69], v[68:69]
    v_pk_mul_f32 v[178:179], v[70:71], v[70:71]
    v_pk_fma_f32 v[172:173], v[172:173], v[18:19], v[16:17]
    v_pk_fma_f32 v[174:175], v[174:175], v[18:19], v[16:17]
    v_pk_fma_f32 v[176:177], v[176:177], v[18:19], v[16:17]
    v_pk_fma_f32 v[178:179], v[178:179], v[18:19], v[16:17]
    v_pk_mul_f32 v[172:173], v[172:173], v[40:41]
    v_pk_mul_f32 v[174:175], v[174:175], v[42:43]
    v_pk_mul_f32 v[176:177], v[176:177], v[68:69]
    v_pk_mul_f32 v[178:179], v[178:179], v[70:71]
    v_exp_f32 v172, v172
    v_exp_f32 v173, v173
    v_exp_f32 v174, v174
    v_exp_f32 v175, v175
    v_exp_f32 v176, v176
    v_exp_f32 v177, v177
    v_exp_f32 v178, v178
    v_exp_f32 v179, v179
    v_pk_add_f32 v[172:173], v[172:173], v[20:21]
    v_pk_add_f32 v[174:175], v[174:175], v[20:21]
    v_pk_add_f32 v[176:177], v[176:177], v[20:21]
    v_pk_add_f32 v[178:179], v[178:179], v[20:21]
    v_rcp_f32 v172, v172
    v_rcp_f32 v173, v173
    v_rcp_f32 v174, v174
    v_rcp_f32 v175, v175
    v_rcp_f32 v176, v176
    v_rcp_f32 v177, v177
    v_rcp_f32 v178, v178
    v_rcp_f32 v179, v179
    v_pk_mul_f32 v[40:41], v[40:41], v[172:173]
    v_pk_mul_f32 v[42:43], v[42:43], v[174:175]
    v_pk_mul_f32 v[68:69], v[68:69], v[176:177]
    v_pk_mul_f32 v[70:71], v[70:71], v[178:179]
    v_cvt_pk_bf16_f32 v96, v40, v41
    v_cvt_pk_bf16_f32 v97, v42, v43
    v_cvt_pk_bf16_f32 v100, v68, v69
    v_cvt_pk_bf16_f32 v101, v70, v71
    v_pk_mul_f32 v[172:173], v[44:45], v[44:45]
    v_pk_mul_f32 v[174:175], v[46:47], v[46:47]
    v_pk_mul_f32 v[176:177], v[72:73], v[72:73]
    v_pk_mul_f32 v[178:179], v[74:75], v[74:75]
    v_pk_fma_f32 v[172:173], v[172:173], v[18:19], v[16:17]
    v_pk_fma_f32 v[174:175], v[174:175], v[18:19], v[16:17]
    v_pk_fma_f32 v[176:177], v[176:177], v[18:19], v[16:17]
    v_pk_fma_f32 v[178:179], v[178:179], v[18:19], v[16:17]
    v_pk_mul_f32 v[172:173], v[172:173], v[44:45]
    v_pk_mul_f32 v[174:175], v[174:175], v[46:47]
    v_pk_mul_f32 v[176:177], v[176:177], v[72:73]
    v_pk_mul_f32 v[178:179], v[178:179], v[74:75]
    v_exp_f32 v172, v172
    v_exp_f32 v173, v173
    v_exp_f32 v174, v174
    v_exp_f32 v175, v175
    v_exp_f32 v176, v176
    v_exp_f32 v177, v177
    v_exp_f32 v178, v178
    v_exp_f32 v179, v179
    v_pk_add_f32 v[172:173], v[172:173], v[20:21]
    v_pk_add_f32 v[174:175], v[174:175], v[20:21]
    v_pk_add_f32 v[176:177], v[176:177], v[20:21]
    v_pk_add_f32 v[178:179], v[178:179], v[20:21]
    v_rcp_f32 v172, v172
    v_rcp_f32 v173, v173
    v_rcp_f32 v174, v174
    v_rcp_f32 v175, v175
    v_rcp_f32 v176, v176
    v_rcp_f32 v177, v177
    v_rcp_f32 v178, v178
    v_rcp_f32 v179, v179
    v_pk_mul_f32 v[44:45], v[44:45], v[172:173]
    v_pk_mul_f32 v[46:47], v[46:47], v[174:175]
    v_pk_mul_f32 v[72:73], v[72:73], v[176:177]
    v_pk_mul_f32 v[74:75], v[74:75], v[178:179]
    v_cvt_pk_bf16_f32 v98, v44, v45
    v_cvt_pk_bf16_f32 v99, v46, v47
    v_cvt_pk_bf16_f32 v102, v72, v73
    v_cvt_pk_bf16_f32 v103, v74, v75
    s_cmp_lg_u32 s91, 0
    s_cbranch_scc1 XS_17
    buffer_store_dwordx4 v[96:99], v3, s[12:15], s33 offen offset:1024 sc1
    buffer_store_dwordx4 v[100:103], v3, s[12:15], s35 offen offset:1024 sc1
    s_branch XS_18
XS_17:
    buffer_store_dwordx4 v[96:99], v3, s[12:15], s33 offen offset:1024
    buffer_store_dwordx4 v[100:103], v3, s[12:15], s35 offen offset:1024
XS_18:
    v_pk_mul_f32 v[172:173], v[48:49], v[48:49]
    v_pk_mul_f32 v[174:175], v[50:51], v[50:51]
    v_pk_mul_f32 v[176:177], v[76:77], v[76:77]
    v_pk_mul_f32 v[178:179], v[78:79], v[78:79]
    v_pk_fma_f32 v[172:173], v[172:173], v[18:19], v[16:17]
    v_pk_fma_f32 v[174:175], v[174:175], v[18:19], v[16:17]
    v_pk_fma_f32 v[176:177], v[176:177], v[18:19], v[16:17]
    v_pk_fma_f32 v[178:179], v[178:179], v[18:19], v[16:17]
    v_pk_mul_f32 v[172:173], v[172:173], v[48:49]
    v_pk_mul_f32 v[174:175], v[174:175], v[50:51]
    v_pk_mul_f32 v[176:177], v[176:177], v[76:77]
    v_pk_mul_f32 v[178:179], v[178:179], v[78:79]
    v_exp_f32 v172, v172
    v_exp_f32 v173, v173
    v_exp_f32 v174, v174
    v_exp_f32 v175, v175
    v_exp_f32 v176, v176
    v_exp_f32 v177, v177
    v_exp_f32 v178, v178
    v_exp_f32 v179, v179
    v_pk_add_f32 v[172:173], v[172:173], v[20:21]
    v_pk_add_f32 v[174:175], v[174:175], v[20:21]
    v_pk_add_f32 v[176:177], v[176:177], v[20:21]
    v_pk_add_f32 v[178:179], v[178:179], v[20:21]
    v_rcp_f32 v172, v172
    v_rcp_f32 v173, v173
    v_rcp_f32 v174, v174
    v_rcp_f32 v175, v175
    v_rcp_f32 v176, v176
    v_rcp_f32 v177, v177
    v_rcp_f32 v178, v178
    v_rcp_f32 v179, v179
    v_pk_mul_f32 v[48:49], v[48:49], v[172:173]
    v_pk_mul_f32 v[50:51], v[50:51], v[174:175]
    v_pk_mul_f32 v[76:77], v[76:77], v[176:177]
    v_pk_mul_f32 v[78:79], v[78:79], v[178:179]
    v_cvt_pk_bf16_f32 v104, v48, v49
    v_cvt_pk_bf16_f32 v105, v50, v51
    v_cvt_pk_bf16_f32 v108, v76, v77
    v_cvt_pk_bf16_f32 v109, v78, v79
    v_pk_mul_f32 v[172:173], v[52:53], v[52:53]
    v_pk_mul_f32 v[174:175], v[54:55], v[54:55]
    v_pk_mul_f32 v[176:177], v[80:81], v[80:81]
    v_pk_mul_f32 v[178:179], v[82:83], v[82:83]
    v_pk_fma_f32 v[172:173], v[172:173], v[18:19], v[16:17]
    v_pk_fma_f32 v[174:175], v[174:175], v[18:19], v[16:17]
    v_pk_fma_f32 v[176:177], v[176:177], v[18:19], v[16:17]
    v_pk_fma_f32 v[178:179], v[178:179], v[18:19], v[16:17]
    v_pk_mul_f32 v[172:173], v[172:173], v[52:53]
    v_pk_mul_f32 v[174:175], v[174:175], v[54:55]
    v_pk_mul_f32 v[176:177], v[176:177], v[80:81]
    v_pk_mul_f32 v[178:179], v[178:179], v[82:83]
    v_exp_f32 v172, v172
    v_exp_f32 v173, v173
    v_exp_f32 v174, v174
    v_exp_f32 v175, v175
    v_exp_f32 v176, v176
    v_exp_f32 v177, v177
    v_exp_f32 v178, v178
    v_exp_f32 v179, v179
    v_pk_add_f32 v[172:173], v[172:173], v[20:21]
    v_pk_add_f32 v[174:175], v[174:175], v[20:21]
    v_pk_add_f32 v[176:177], v[176:177], v[20:21]
    v_pk_add_f32 v[178:179], v[178:179], v[20:21]
    v_rcp_f32 v172, v172
    v_rcp_f32 v173, v173
    v_rcp_f32 v174, v174
    v_rcp_f32 v175, v175
    v_rcp_f32 v176, v176
    v_rcp_f32 v177, v177
    v_rcp_f32 v178, v178
    v_rcp_f32 v179, v179
    v_pk_mul_f32 v[52:53], v[52:53], v[172:173]
    v_pk_mul_f32 v[54:55], v[54:55], v[174:175]
    v_pk_mul_f32 v[80:81], v[80:81], v[176:177]
    v_pk_mul_f32 v[82:83], v[82:83], v[178:179]
    v_cvt_pk_bf16_f32 v106, v52, v53
    v_cvt_pk_bf16_f32 v107, v54, v55
    v_cvt_pk_bf16_f32 v110, v80, v81
    v_cvt_pk_bf16_f32 v111, v82, v83
    s_cmp_lg_u32 s91, 0
    s_cbranch_scc1 XS_19
    buffer_store_dwordx4 v[104:107], v3, s[12:15], s33 offen offset:2048 sc1
    buffer_store_dwordx4 v[108:111], v3, s[12:15], s35 offen offset:2048 sc1
    s_branch XS_20
XS_19:
    buffer_store_dwordx4 v[104:107], v3, s[12:15], s33 offen offset:2048
    buffer_store_dwordx4 v[108:111], v3, s[12:15], s35 offen offset:2048
XS_20:
    s_nop 1
    s_and_b32 s32, s29, 3
    s_cmp_eq_u32 s32, 0
    s_cbranch_scc1 M_NOLEFT
    v_pk_mul_f32 v[172:173], v[56:57], v[56:57]
    v_pk_mul_f32 v[174:175], v[58:59], v[58:59]
    v_pk_mul_f32 v[176:177], v[84:85], v[84:85]
    v_pk_mul_f32 v[178:179], v[86:87], v[86:87]
    v_pk_fma_f32 v[172:173], v[172:173], v[18:19], v[16:17]
    v_pk_fma_f32 v[174:175], v[174:175], v[18:19], v[16:17]
    v_pk_fma_f32 v[176:177], v[176:177], v[18:19], v[16:17]
    v_pk_fma_f32 v[178:179], v[178:179], v[18:19], v[16:17]
    v_pk_mul_f32 v[172:173], v[172:173], v[56:57]
    v_pk_mul_f32 v[174:175], v[174:175], v[58:59]
    v_pk_mul_f32 v[176:177], v[176:177], v[84:85]
    v_pk_mul_f32 v[178:179], v[178:179], v[86:87]
    v_exp_f32 v172, v172
    v_exp_f32 v173, v173
    v_exp_f32 v174, v174
    v_exp_f32 v175, v175
    v_exp_f32 v176, v176
    v_exp_f32 v177, v177
    v_exp_f32 v178, v178
    v_exp_f32 v179, v179
    v_pk_add_f32 v[172:173], v[172:173], v[20:21]
    v_pk_add_f32 v[174:175], v[174:175], v[20:21]
    v_pk_add_f32 v[176:177], v[176:177], v[20:21]
    v_pk_add_f32 v[178:179], v[178:179], v[20:21]
    v_rcp_f32 v172, v172
    v_rcp_f32 v173, v173
    v_rcp_f32 v174, v174
    v_rcp_f32 v175, v175
    v_rcp_f32 v176, v176
    v_rcp_f32 v177, v177
    v_rcp_f32 v178, v178
    v_rcp_f32 v179, v179
    v_pk_mul_f32 v[56:57], v[56:57], v[172:173]
    v_pk_mul_f32 v[58:59], v[58:59], v[174:175]
    v_pk_mul_f32 v[84:85], v[84:85], v[176:177]
    v_pk_mul_f32 v[86:87], v[86:87], v[178:179]
    v_cvt_pk_bf16_f32 v112, v56, v57
    v_cvt_pk_bf16_f32 v113, v58, v59
    v_cvt_pk_bf16_f32 v114, v84, v85
    v_cvt_pk_bf16_f32 v115, v86, v87
    s_cmp_lg_u32 s91, 0
    s_cbranch_scc1 XS_21
    buffer_store_dwordx4 v[112:115], v3, s[12:15], s34 offen sc1
    s_branch XS_22
XS_21:
    buffer_store_dwordx4 v[112:115], v3, s[12:15], s34 offen
XS_22:
M_NOLEFT:
    s_lshl_b32 s30, s22, 2
    s_add_u32 s30, s30, s3
    s_lshl_b32 s30, s30, 4
    s_add_u32 s30, s30, s29
    s_lshl_b32 s30, s30, 7
    s_add_u32 s30, s30, 524288
    v_mov_b32 v16, 1
    v_mov_b32 v17, 0
    s_waitcnt vmcnt(0)
    s_mov_b64 exec, 1
    s_cmp_lg_u32 s91, 0
    s_cbranch_scc1 XS_23
    buffer_store_dword v16, v17, s[12:15], s30 offen sc1
    s_branch XS_24
XS_23:
    buffer_store_dword v16, v17, s[12:15], s30 offen
XS_24:
    s_mov_b64 exec, -1
    s_barrier
    s_lshl_b32 s26, s3, 11
    s_and_b32 s27, s3, 1
    s_lshl_b32 s27, s27, 10
    s_sub_u32 s26, s26, s27
    v_add_u32 v10, s26, v3
    v_add_u32 v13, s27, v3
    s_mul_i32 s26, s3, 5120
    v_add_u32 v14, s26, v3
    s_xor_b32 s27, s3, 1
    s_mul_i32 s27, s27, 5120
    v_add_u32 v15, s27, v3
    s_and_b32 s27, s3, 1
    s_cmp_eq_u32 s27, 1
    s_cselect_b64 s[46:47], -1, 0
    s_mov_b32 s36, s98
    s_and_b32 s37, s99, 0xffff
    s_mov_b32 s38, 2621440
    s_mov_b32 s39, 0x00020000
    v_cndmask_b32 v204, v204, 0, s[46:47]
    v_cndmask_b32 v205, v205, 0, s[46:47]
    v_cndmask_b32 v206, v206, 0, s[46:47]
    v_cndmask_b32 v207, v207, 0, s[46:47]
    v_cndmask_b32 v208, v208, 0, s[46:47]
    v_cndmask_b32 v209, v209, 0, s[46:47]
    v_cndmask_b32 v210, v210, 0, s[46:47]
    v_cndmask_b32 v211, v211, 0, s[46:47]
    v_cndmask_b32 v212, v212, 0, s[46:47]
    v_cndmask_b32 v213, v213, 0, s[46:47]
    v_lshlrev_b32 v32, 16, v204
    v_and_b32 v33, 0xffff0000, v204
    v_lshlrev_b32 v34, 16, v205
    v_and_b32 v35, 0xffff0000, v205
    v_lshlrev_b32 v36, 16, v206
    v_and_b32 v37, 0xffff0000, v206
    v_lshlrev_b32 v38, 16, v207
    v_and_b32 v39, 0xffff0000, v207
    v_lshlrev_b32 v40, 16, v208
    v_and_b32 v41, 0xffff0000, v208
    v_lshlrev_b32 v42, 16, v209
    v_and_b32 v43, 0xffff0000, v209
    v_lshlrev_b32 v44, 16, v210
    v_and_b32 v45, 0xffff0000, v210
    v_lshlrev_b32 v46, 16, v211
    v_and_b32 v47, 0xffff0000, v211
    v_lshlrev_b32 v48, 16, v212
    v_and_b32 v49, 0xffff0000, v212
    v_lshlrev_b32 v50, 16, v213
    v_and_b32 v51, 0xffff0000, v213
    v_lshlrev_b32 v52, 16, v204
    v_and_b32 v53, 0xffff0000, v204
    v_lshlrev_b32 v54, 16, v205
    v_and_b32 v55, 0xffff0000, v205
    v_lshlrev_b32 v56, 16, v206
    v_and_b32 v57, 0xffff0000, v206
    v_lshlrev_b32 v58, 16, v207
    v_and_b32 v59, 0xffff0000, v207
    v_lshlrev_b32 v60, 16, v208
    v_and_b32 v61, 0xffff0000, v208
    v_lshlrev_b32 v62, 16, v209
    v_and_b32 v63, 0xffff0000, v209
    v_lshlrev_b32 v64, 16, v210
    v_and_b32 v65, 0xffff0000, v210
    v_lshlrev_b32 v66, 16, v211
    v_and_b32 v67, 0xffff0000, v211
    v_lshlrev_b32 v68, 16, v212
    v_and_b32 v69, 0xffff0000, v212
    v_lshlrev_b32 v70, 16, v213
    v_and_b32 v71, 0xffff0000, v213
    s_mov_b32 s56, 0
    s_mov_b32 s57, 49152
    v_add_u32 v12, s57, v13
    v_add_u32 v11, s56, v10
    s_add_u32 s56, s56, 8192
    s_cmp_ge_u32 s56, 49152
    s_cselect_b32 s56, 0, s56
    s_add_u32 s57, s57, 10240
    s_cmp_ge_u32 s57, 161792
    s_cselect_b32 s57, 49152, s57
    s_waitcnt lgkmcnt(0)
    s_barrier
    ds_read_b128 v[72:75], v11
    ds_read_b128 v[76:79], v11 offset:2048
    ds_read_b128 v[88:91], v12 offset:0
    ds_read_b128 v[92:95], v12 offset:2048
    ds_read_b128 v[96:99], v12 offset:4096
    ds_read_b128 v[100:103], v12 offset:6144
    ds_read_b128 v[104:107], v12 offset:8192
    v_add_u32 v12, s57, v13
    v_add_u32 v11, s56, v10
    s_add_u32 s56, s56, 8192
    s_cmp_ge_u32 s56, 49152
    s_cselect_b32 s56, 0, s56
    s_add_u32 s57, s57, 10240
    s_cmp_ge_u32 s57, 161792
    s_cselect_b32 s57, 49152, s57
    s_mov_b32 s58, 11
C4_L:
    s_waitcnt lgkmcnt(0)
    s_barrier
    v_mfma_f32_16x16x32_bf16 v[32:35], v[88:91], v[72:75], v[32:35]
    ds_read_b128 v[80:83], v11
    ds_read_b128 v[84:87], v11 offset:2048
    v_mfma_f32_16x16x32_bf16 v[52:55], v[88:91], v[76:79], v[52:55]
    ds_read_b128 v[108:111], v12 offset:0
    ds_read_b128 v[112:115], v12 offset:2048
    v_mfma_f32_16x16x32_bf16 v[36:39], v[92:95], v[72:75], v[36:39]
    ds_read_b128 v[116:119], v12 offset:4096
    ds_read_b128 v[120:123], v12 offset:6144
    v_mfma_f32_16x16x32_bf16 v[56:59], v[92:95], v[76:79], v[56:59]
    ds_read_b128 v[124:127], v12 offset:8192
    v_add_u32 v12, s57, v13
    v_mfma_f32_16x16x32_bf16 v[40:43], v[96:99], v[72:75], v[40:43]
    v_add_u32 v11, s56, v10
    s_add_u32 s56, s56, 8192
    v_mfma_f32_16x16x32_bf16 v[60:63], v[96:99], v[76:79], v[60:63]
    s_cmp_ge_u32 s56, 49152
    s_cselect_b32 s56, 0, s56
    v_mfma_f32_16x16x32_bf16 v[44:47], v[100:103], v[72:75], v[44:47]
    s_add_u32 s57, s57, 10240
    s_cmp_ge_u32 s57, 161792
    v_mfma_f32_16x16x32_bf16 v[64:67], v[100:103], v[76:79], v[64:67]
    s_cselect_b32 s57, 49152, s57
    v_mfma_f32_16x16x32_bf16 v[48:51], v[104:107], v[72:75], v[48:51]
    v_mfma_f32_16x16x32_bf16 v[68:71], v[104:107], v[76:79], v[68:71]
    s_waitcnt lgkmcnt(0)
    s_barrier
    v_mfma_f32_16x16x32_bf16 v[32:35], v[108:111], v[80:83], v[32:35]
    ds_read_b128 v[72:75], v11
    ds_read_b128 v[76:79], v11 offset:2048
    v_mfma_f32_16x16x32_bf16 v[52:55], v[108:111], v[84:87], v[52:55]
    ds_read_b128 v[88:91], v12 offset:0
    ds_read_b128 v[92:95], v12 offset:2048
    v_mfma_f32_16x16x32_bf16 v[36:39], v[112:115], v[80:83], v[36:39]
    ds_read_b128 v[96:99], v12 offset:4096
    ds_read_b128 v[100:103], v12 offset:6144
    v_mfma_f32_16x16x32_bf16 v[56:59], v[112:115], v[84:87], v[56:59]
    ds_read_b128 v[104:107], v12 offset:8192
    v_add_u32 v12, s57, v13
    v_mfma_f32_16x16x32_bf16 v[40:43], v[116:119], v[80:83], v[40:43]
    v_add_u32 v11, s56, v10
    s_add_u32 s56, s56, 8192
    v_mfma_f32_16x16x32_bf16 v[60:63], v[116:119], v[84:87], v[60:63]
    s_cmp_ge_u32 s56, 49152
    s_cselect_b32 s56, 0, s56
    v_mfma_f32_16x16x32_bf16 v[44:47], v[120:123], v[80:83], v[44:47]
    s_add_u32 s57, s57, 10240
    s_cmp_ge_u32 s57, 161792
    v_mfma_f32_16x16x32_bf16 v[64:67], v[120:123], v[84:87], v[64:67]
    s_cselect_b32 s57, 49152, s57
    s_sub_u32 s58, s58, 1
    v_mfma_f32_16x16x32_bf16 v[48:51], v[124:127], v[80:83], v[48:51]
    s_cmp_lg_u32 s58, 0
    v_mfma_f32_16x16x32_bf16 v[68:71], v[124:127], v[84:87], v[68:71]
    s_cbranch_scc1 C4_L
    s_waitcnt lgkmcnt(0)
    s_barrier
    v_mfma_f32_16x16x32_bf16 v[32:35], v[88:91], v[72:75], v[32:35]
    ds_read_b128 v[80:83], v11
    ds_read_b128 v[84:87], v11 offset:2048
    v_mfma_f32_16x16x32_bf16 v[52:55], v[88:91], v[76:79], v[52:55]
    ds_read_b128 v[108:111], v12 offset:0
    ds_read_b128 v[112:115], v12 offset:2048
    v_mfma_f32_16x16x32_bf16 v[36:39], v[92:95], v[72:75], v[36:39]
    ds_read_b128 v[116:119], v12 offset:4096
    ds_read_b128 v[120:123], v12 offset:6144
    v_mfma_f32_16x16x32_bf16 v[56:59], v[92:95], v[76:79], v[56:59]
    ds_read_b128 v[124:127], v12 offset:8192
    v_add_u32 v12, s57, v13
    v_mfma_f32_16x16x32_bf16 v[40:43], v[96:99], v[72:75], v[40:43]
    v_add_u32 v11, s56, v10
    s_add_u32 s56, s56, 8192
    v_mfma_f32_16x16x32_bf16 v[60:63], v[96:99], v[76:79], v[60:63]
    s_cmp_ge_u32 s56, 49152
    s_cselect_b32 s56, 0, s56
    v_mfma_f32_16x16x32_bf16 v[44:47], v[100:103], v[72:75], v[44:47]
    s_add_u32 s57, s57, 10240
    s_cmp_ge_u32 s57, 161792
    v_mfma_f32_16x16x32_bf16 v[64:67], v[100:103], v[76:79], v[64:67]
    s_cselect_b32 s57, 49152, s57
    v_mfma_f32_16x16x32_bf16 v[48:51], v[104:107], v[72:75], v[48:51]
    v_mfma_f32_16x16x32_bf16 v[68:71], v[104:107], v[76:79], v[68:71]
    s_waitcnt lgkmcnt(0)
    s_barrier
    v_mfma_f32_16x16x32_bf16 v[32:35], v[108:111], v[80:83], v[32:35]
    ds_read_b64 v[72:73], v11
    ds_read_b64 v[74:75], v11 offset:2048
    v_mfma_f32_16x16x32_bf16 v[52:55], v[108:111], v[84:87], v[52:55]
    ds_read_b64 v[76:77], v11 offset:8
    ds_read_b64 v[78:79], v11 offset:2056
    v_mfma_f32_16x16x32_bf16 v[36:39], v[112:115], v[80:83], v[36:39]
    ds_read_b128 v[88:91], v12 offset:0
    ds_read_b128 v[92:95], v12 offset:2048
    v_mfma_f32_16x16x32_bf16 v[56:59], v[112:115], v[84:87], v[56:59]
    ds_read_b128 v[96:99], v12 offset:4096
    ds_read_b128 v[100:103], v12 offset:6144
    v_mfma_f32_16x16x32_bf16 v[40:43], v[116:119], v[80:83], v[40:43]
    ds_read_b128 v[104:107], v12 offset:8192
    v_add_u32 v12, s57, v13
    v_mfma_f32_16x16x32_bf16 v[60:63], v[116:119], v[84:87], v[60:63]
    v_add_u32 v11, s56, v10
    s_add_u32 s56, s56, 8192
    v_mfma_f32_16x16x32_bf16 v[44:47], v[120:123], v[80:83], v[44:47]
    s_cmp_ge_u32 s56, 49152
    s_cselect_b32 s56, 0, s56
    v_mfma_f32_16x16x32_bf16 v[64:67], v[120:123], v[84:87], v[64:67]
    s_add_u32 s57, s57, 10240
    s_cmp_ge_u32 s57, 161792
    v_mfma_f32_16x16x32_bf16 v[48:51], v[124:127], v[80:83], v[48:51]
    s_cselect_b32 s57, 49152, s57
    v_mfma_f32_16x16x32_bf16 v[68:71], v[124:127], v[84:87], v[68:71]
    s_waitcnt lgkmcnt(0)
    s_barrier
    v_mfma_f32_16x16x32_bf16 v[32:35], v[88:91], v[72:75], v[32:35]
    ds_read_b64 v[80:81], v11
    ds_read_b64 v[82:83], v11 offset:2048
    v_mfma_f32_16x16x32_bf16 v[52:55], v[88:91], v[76:79], v[52:55]
    ds_read_b64 v[84:85], v11 offset:8
    ds_read_b64 v[86:87], v11 offset:2056
    v_mfma_f32_16x16x32_bf16 v[36:39], v[92:95], v[72:75], v[36:39]
    ds_read_b128 v[108:111], v12 offset:0
    ds_read_b128 v[112:115], v12 offset:2048
    v_mfma_f32_16x16x32_bf16 v[56:59], v[92:95], v[76:79], v[56:59]
    ds_read_b128 v[116:119], v12 offset:4096
    ds_read_b128 v[120:123], v12 offset:6144
    v_mfma_f32_16x16x32_bf16 v[40:43], v[96:99], v[72:75], v[40:43]
    ds_read_b128 v[124:127], v12 offset:8192
    v_add_u32 v12, s57, v13
    v_mfma_f32_16x16x32_bf16 v[60:63], v[96:99], v[76:79], v[60:63]
    v_add_u32 v11, s56, v10
    s_add_u32 s56, s56, 8192
    v_mfma_f32_16x16x32_bf16 v[44:47], v[100:103], v[72:75], v[44:47]
    s_cmp_ge_u32 s56, 49152
    s_cselect_b32 s56, 0, s56
    v_mfma_f32_16x16x32_bf16 v[64:67], v[100:103], v[76:79], v[64:67]
    s_add_u32 s57, s57, 10240
    s_cmp_ge_u32 s57, 161792
    v_mfma_f32_16x16x32_bf16 v[48:51], v[104:107], v[72:75], v[48:51]
    s_cselect_b32 s57, 49152, s57
    v_mfma_f32_16x16x32_bf16 v[68:71], v[104:107], v[76:79], v[68:71]
    s_waitcnt lgkmcnt(0)
    s_barrier
    v_mfma_f32_16x16x32_bf16 v[32:35], v[108:111], v[80:83], v[32:35]
    ds_read_b64 v[72:73], v11
    ds_read_b64 v[74:75], v11 offset:2048
    v_mfma_f32_16x16x32_bf16 v[52:55], v[108:111], v[84:87], v[52:55]
    ds_read_b64 v[76:77], v11 offset:8
    ds_read_b64 v[78:79], v11 offset:2056
    v_mfma_f32_16x16x32_bf16 v[36:39], v[112:115], v[80:83], v[36:39]
    ds_read_b128 v[88:91], v12 offset:0
    ds_read_b128 v[92:95], v12 offset:2048
    v_mfma_f32_16x16x32_bf16 v[56:59], v[112:115], v[84:87], v[56:59]
    ds_read_b128 v[96:99], v12 offset:4096
    ds_read_b128 v[100:103], v12 offset:6144
    v_mfma_f32_16x16x32_bf16 v[40:43], v[116:119], v[80:83], v[40:43]
    ds_read_b128 v[104:107], v12 offset:8192
    v_add_u32 v12, s57, v13
    v_mfma_f32_16x16x32_bf16 v[60:63], v[116:119], v[84:87], v[60:63]
    v_add_u32 v11, s56, v10
    s_add_u32 s56, s56, 8192
    v_mfma_f32_16x16x32_bf16 v[44:47], v[120:123], v[80:83], v[44:47]
    s_cmp_ge_u32 s56, 49152
    s_cselect_b32 s56, 0, s56
    v_mfma_f32_16x16x32_bf16 v[64:67], v[120:123], v[84:87], v[64:67]
    s_add_u32 s57, s57, 10240
    s_cmp_ge_u32 s57, 161792
    v_mfma_f32_16x16x32_bf16 v[48:51], v[124:127], v[80:83], v[48:51]
    s_cselect_b32 s57, 49152, s57
    v_mfma_f32_16x16x32_bf16 v[68:71], v[124:127], v[84:87], v[68:71]
    s_waitcnt lgkmcnt(0)
    s_barrier
    v_mfma_f32_16x16x32_bf16 v[32:35], v[88:91], v[72:75], v[32:35]
    v_mfma_f32_16x16x32_bf16 v[52:55], v[88:91], v[76:79], v[52:55]
    v_mfma_f32_16x16x32_bf16 v[36:39], v[92:95], v[72:75], v[36:39]
    v_mfma_f32_16x16x32_bf16 v[56:59], v[92:95], v[76:79], v[56:59]
    v_mfma_f32_16x16x32_bf16 v[40:43], v[96:99], v[72:75], v[40:43]
    v_mfma_f32_16x16x32_bf16 v[60:63], v[96:99], v[76:79], v[60:63]
    v_mfma_f32_16x16x32_bf16 v[44:47], v[100:103], v[72:75], v[44:47]
    v_mfma_f32_16x16x32_bf16 v[64:67], v[100:103], v[76:79], v[64:67]
    v_mfma_f32_16x16x32_bf16 v[48:51], v[104:107], v[72:75], v[48:51]
    v_mfma_f32_16x16x32_bf16 v[68:71], v[104:107], v[76:79], v[68:71]
    s_cmp_eq_u32 s27, 1
    s_cbranch_scc1 X4_25
    ds_write_b128 v15, v[52:55] offset:0
    ds_write_b128 v15, v[56:59] offset:1024
    ds_write_b128 v15, v[60:63] offset:2048
    s_nop 0
    ds_write_b128 v15, v[64:67] offset:3072
    s_nop 0
    ds_write_b128 v15, v[68:71] offset:4096
    s_branch X4_26
X4_25:
    s_nop 5
    ds_write_b128 v15, v[32:35] offset:0
    ds_write_b128 v15, v[36:39] offset:1024
    ds_write_b128 v15, v[40:43] offset:2048
    ds_write_b128 v15, v[44:47] offset:3072
    ds_write_b128 v15, v[48:51] offset:4096
    v_pk_add_f32 v[32:33], v[52:53], 0
    v_pk_add_f32 v[34:35], v[54:55], 0
    v_pk_add_f32 v[36:37], v[56:57], 0
    v_pk_add_f32 v[38:39], v[58:59], 0
    v_pk_add_f32 v[40:41], v[60:61], 0
    v_pk_add_f32 v[42:43], v[62:63], 0
    v_pk_add_f32 v[44:45], v[64:65], 0
    v_pk_add_f32 v[46:47], v[66:67], 0
    v_pk_add_f32 v[48:49], v[68:69], 0
    v_pk_add_f32 v[50:51], v[70:71], 0
X4_26:
    s_nop 1
    s_waitcnt lgkmcnt(0)
    s_barrier
    ds_read_b128 v[52:55], v14 offset:0
    ds_read_b128 v[56:59], v14 offset:1024
    ds_read_b128 v[60:63], v14 offset:2048
    ds_read_b128 v[64:67], v14 offset:3072
    ds_read_b128 v[68:71], v14 offset:4096
    v_lshlrev_b32 v88, 16, v240
    v_and_b32 v89, 0xffff0000, v240
    v_lshlrev_b32 v90, 16, v241
    v_and_b32 v91, 0xffff0000, v241
    v_lshlrev_b32 v92, 16, v242
    v_and_b32 v93, 0xffff0000, v242
    v_lshlrev_b32 v94, 16, v243
    v_and_b32 v95, 0xffff0000, v243
    v_lshlrev_b32 v96, 16, v244
    v_and_b32 v97, 0xffff0000, v244
    v_lshlrev_b32 v98, 16, v245
    v_and_b32 v99, 0xffff0000, v245
    v_lshlrev_b32 v100, 16, v246
    v_and_b32 v101, 0xffff0000, v246
    v_lshlrev_b32 v102, 16, v247
    v_and_b32 v103, 0xffff0000, v247
    v_lshlrev_b32 v104, 16, v248
    v_and_b32 v105, 0xffff0000, v248
    v_lshlrev_b32 v106, 16, v249
    v_and_b32 v107, 0xffff0000, v249
    s_waitcnt lgkmcnt(0)
    v_pk_add_f32 v[32:33], v[32:33], v[52:53]
    v_pk_add_f32 v[34:35], v[34:35], v[54:55]
    v_pk_add_f32 v[36:37], v[36:37], v[56:57]
    v_pk_add_f32 v[38:39], v[38:39], v[58:59]
    v_pk_add_f32 v[40:41], v[40:41], v[60:61]
    v_pk_add_f32 v[42:43], v[42:43], v[62:63]
    v_pk_add_f32 v[44:45], v[44:45], v[64:65]
    v_pk_add_f32 v[46:47], v[46:47], v[66:67]
    v_pk_add_f32 v[48:49], v[48:49], v[68:69]
    v_pk_add_f32 v[50:51], v[50:51], v[70:71]
    v_pk_fma_f32 v[88:89], v[214:215], v[32:33], v[88:89]
    v_pk_fma_f32 v[90:91], v[216:217], v[34:35], v[90:91]
    v_cvt_pk_bf16_f32 v240, v88, v89
    v_cvt_pk_bf16_f32 v241, v90, v91
    buffer_store_dwordx2 v[240:241], v9, s[36:39], s42 offen offset:0
    v_pk_fma_f32 v[92:93], v[218:219], v[36:37], v[92:93]
    v_pk_fma_f32 v[94:95], v[220:221], v[38:39], v[94:95]
    v_cvt_pk_bf16_f32 v242, v92, v93
    v_cvt_pk_bf16_f32 v243, v94, v95
    buffer_store_dwordx2 v[242:243], v9, s[36:39], s42 offen offset:32
    v_pk_fma_f32 v[96:97], v[222:223], v[40:41], v[96:97]
    v_pk_fma_f32 v[98:99], v[224:225], v[42:43], v[98:99]
    v_cvt_pk_bf16_f32 v244, v96, v97
    v_cvt_pk_bf16_f32 v245, v98, v99
    buffer_store_dwordx2 v[244:245], v9, s[36:39], s42 offen offset:64
    v_pk_fma_f32 v[100:101], v[226:227], v[44:45], v[100:101]
    v_pk_fma_f32 v[102:103], v[228:229], v[46:47], v[102:103]
    v_cvt_pk_bf16_f32 v246, v100, v101
    v_cvt_pk_bf16_f32 v247, v102, v103
    buffer_store_dwordx2 v[246:247], v9, s[36:39], s42 offen offset:96
    v_pk_fma_f32 v[104:105], v[230:231], v[48:49], v[104:105]
    v_pk_fma_f32 v[106:107], v[232:233], v[50:51], v[106:107]
    v_cvt_pk_bf16_f32 v248, v104, v105
    v_cvt_pk_bf16_f32 v249, v106, v107
    buffer_store_dwordx2 v[248:249], v9, s[36:39], s42 offen offset:128
    s_endpgm
M_LOADER:
    s_and_b32 s26, s3, 1
    s_mul_i32 s45, s20, 81920
    s_add_u32 s45, s45, 15728640
    s_mul_i32 s46, s21, 102400
    s_add_u32 s46, s46, 2097152
    s_mul_i32 s25, s22, 163840
    s_add_u32 s25, s25, 18874368
    s_mul_i32 s27, s23, 20480
    s_add_u32 s27, s27, 3145728
    s_mul_i32 s43, s20, 221184
    s_add_u32 s43, s43, 22020096
    s_mul_i32 s44, s21, 276480
    s_add_u32 s44, s44, 6291456
    s_cmp_ge_u32 s3, 6
    s_cbranch_scc1 M_BLOADER
    v_and_b32 v4, 7, v1
    v_lshlrev_b32 v4, 10, v4
    s_and_b32 s30, s2, 0xc7
    s_lshl_b32 s30, s30, 7
    s_add_u32 s30, s30, 720896
    s_mul_i32 s60, s26, 1024
    s_add_u32 s72, s60, 0
    s_add_u32 s60, s60, 0
    s_add_u32 s60, s60, s45
    s_mul_i32 s61, s26, 1024
    s_add_u32 s73, s61, 2048
    s_add_u32 s61, s61, 20480
    s_add_u32 s61, s61, s45
    s_mul_i32 s62, s26, 1024
    s_add_u32 s74, s62, 4096
    s_add_u32 s62, s62, 40960
    s_add_u32 s62, s62, s45
    s_mul_i32 s63, s26, 1024
    s_add_u32 s75, s63, 6144
    s_add_u32 s63, s63, 61440
    s_add_u32 s63, s63, s45
    s_mov_b32 s56, 0
    s_mov_b32 s31, 0
M_POLLB:
    buffer_load_dword v5, v4, s[12:15], s30 offen sc1
    s_add_u32 s31, s31, 1
    s_waitcnt vmcnt(0)
    v_cmp_eq_u32 vcc, 0, v5
    s_cmp_gt_u32 s31, 200000
    s_cselect_b64 s[32:33], 0, vcc
    s_cmp_lg_u64 s[32:33], 0
    s_cbranch_scc1 M_POLLB
    s_mov_b32 s57, 4
LAB_F:
    s_add_u32 m0, s72, s56
    s_nop 0
    buffer_load_dwordx4 v3, s[12:15], s60 offen sc1 lds
    s_add_u32 s60, s60, 2048
    s_add_u32 m0, s73, s56
    s_nop 0
    buffer_load_dwordx4 v3, s[12:15], s61 offen sc1 lds
    s_add_u32 s61, s61, 2048
    s_add_u32 m0, s74, s56
    s_nop 0
    buffer_load_dwordx4 v3, s[12:15], s62 offen sc1 lds
    s_add_u32 s62, s62, 2048
    s_add_u32 m0, s75, s56
    s_nop 0
    buffer_load_dwordx4 v3, s[12:15], s63 offen sc1 lds
    s_add_u32 s63, s63, 2048
    s_add_u32 s56, s56, 8192
    s_cmp_ge_u32 s56, 49152
    s_cselect_b32 s56, 0, s56
    s_sub_u32 s57, s57, 1
    s_cmp_lg_u32 s57, 0
    s_cbranch_scc1 LAB_F
    s_mov_b32 s57, 2
LAB_L:
    s_waitcnt vmcnt(12)
    s_barrier
    s_add_u32 m0, s72, s56
    s_nop 0
    buffer_load_dwordx4 v3, s[12:15], s60 offen sc1 lds
    s_add_u32 s60, s60, 2048
    s_add_u32 m0, s73, s56
    s_nop 0
    buffer_load_dwordx4 v3, s[12:15], s61 offen sc1 lds
    s_add_u32 s61, s61, 2048
    s_add_u32 m0, s74, s56
    s_nop 0
    buffer_load_dwordx4 v3, s[12:15], s62 offen sc1 lds
    s_add_u32 s62, s62, 2048
    s_add_u32 m0, s75, s56
    s_nop 0
    buffer_load_dwordx4 v3, s[12:15], s63 offen sc1 lds
    s_add_u32 s63, s63, 2048
    s_add_u32 s56, s56, 8192
    s_cmp_ge_u32 s56, 49152
    s_cselect_b32 s56, 0, s56
    s_waitcnt vmcnt(12)
    s_barrier
    s_add_u32 m0, s72, s56
    s_nop 0
    buffer_load_dwordx4 v3, s[12:15], s60 offen sc1 lds
    s_add_u32 s60, s60, 2048
    s_add_u32 m0, s73, s56
    s_nop 0
    buffer_load_dwordx4 v3, s[12:15], s61 offen sc1 lds
    s_add_u32 s61, s61, 2048
    s_add_u32 m0, s74, s56
    s_nop 0
    buffer_load_dwordx4 v3, s[12:15], s62 offen sc1 lds
    s_add_u32 s62, s62, 2048
    s_add_u32 m0, s75, s56
    s_nop 0
    buffer_load_dwordx4 v3, s[12:15], s63 offen sc1 lds
    s_add_u32 s63, s63, 2048
    s_add_u32 s56, s56, 8192
    s_cmp_ge_u32 s56, 49152
    s_cselect_b32 s56, 0, s56
    s_waitcnt vmcnt(12)
    s_barrier
    s_add_u32 m0, s72, s56
    s_nop 0
    buffer_load_dwordx4 v3, s[12:15], s60 offen sc1 lds
    s_add_u32 s60, s60, 2048
    s_add_u32 m0, s73, s56
    s_nop 0
    buffer_load_dwordx4 v3, s[12:15], s61 offen sc1 lds
    s_add_u32 s61, s61, 2048
    s_add_u32 m0, s74, s56
    s_nop 0
    buffer_load_dwordx4 v3, s[12:15], s62 offen sc1 lds
    s_add_u32 s62, s62, 2048
    s_add_u32 m0, s75, s56
    s_nop 0
    buffer_load_dwordx4 v3, s[12:15], s63 offen sc1 lds
    s_add_u32 s63, s63, 2048
    s_add_u32 s56, s56, 8192
    s_cmp_ge_u32 s56, 49152
    s_cselect_b32 s56, 0, s56
    s_sub_u32 s57, s57, 1
    s_cmp_lg_u32 s57, 0
    s_cbranch_scc1 LAB_L
    s_waitcnt vmcnt(12)
    s_barrier
    s_waitcnt vmcnt(8)
    s_barrier
    s_waitcnt vmcnt(4)
    s_barrier
    s_waitcnt vmcnt(0)
    s_barrier
    s_barrier
    v_lshlrev_b32 v4, 7, v1
    s_lshl_b32 s30, s22, 13
    s_add_u32 s30, s30, 786432
    s_mul_i32 s60, s26, 1024
    s_add_u32 s72, s60, 0
    s_add_u32 s60, s60, 0
    s_add_u32 s60, s60, s25
    s_mul_i32 s61, s26, 1024
    s_add_u32 s73, s61, 2048
    s_add_u32 s61, s61, 20480
    s_add_u32 s61, s61, s25
    s_mul_i32 s62, s26, 1024
    s_add_u32 s74, s62, 4096
    s_add_u32 s62, s62, 40960
    s_add_u32 s62, s62, s25
    s_mul_i32 s63, s26, 1024
    s_add_u32 s75, s63, 6144
    s_add_u32 s63, s63, 61440
    s_add_u32 s63, s63, s25
    s_mul_i32 s64, s26, 1024
    s_add_u32 s76, s64, 8192
    s_add_u32 s64, s64, 81920
    s_add_u32 s64, s64, s25
    s_mul_i32 s65, s26, 1024
    s_add_u32 s77, s65, 10240
    s_add_u32 s65, s65, 102400
    s_add_u32 s65, s65, s25
    s_mul_i32 s66, s26, 1024
    s_add_u32 s78, s66, 12288
    s_add_u32 s66, s66, 122880
    s_add_u32 s66, s66, s25
    s_mul_i32 s67, s26, 1024
    s_add_u32 s79, s67, 14336
    s_add_u32 s67, s67, 143360
    s_add_u32 s67, s67, s25
    s_mov_b32 s56, 0
    s_barrier
    s_mov_b32 s31, 0
M_POLL3:
    buffer_load_dword v5, v4, s[12:15], s30 offen sc1
    s_add_u32 s31, s31, 1
    s_waitcnt vmcnt(0)
    v_cmp_eq_u32 vcc, 0, v5
    s_cmp_gt_u32 s31, 200000
    s_cselect_b64 s[32:33], 0, vcc
    s_cmp_lg_u64 s[32:33], 0
    s_cbranch_scc1 M_POLL3
    s_mov_b32 s57, 3
LA3_F:
    s_add_u32 m0, s72, s56
    s_nop 0
    buffer_load_dwordx4 v3, s[12:15], s60 offen sc1 lds
    s_add_u32 s60, s60, 2048
    s_add_u32 m0, s73, s56
    s_nop 0
    buffer_load_dwordx4 v3, s[12:15], s61 offen sc1 lds
    s_add_u32 s61, s61, 2048
    s_add_u32 m0, s74, s56
    s_nop 0
    buffer_load_dwordx4 v3, s[12:15], s62 offen sc1 lds
    s_add_u32 s62, s62, 2048
    s_add_u32 m0, s75, s56
    s_nop 0
    buffer_load_dwordx4 v3, s[12:15], s63 offen sc1 lds
    s_add_u32 s63, s63, 2048
    s_add_u32 m0, s76, s56
    s_nop 0
    buffer_load_dwordx4 v3, s[12:15], s64 offen sc1 lds
    s_add_u32 s64, s64, 2048
    s_add_u32 m0, s77, s56
    s_nop 0
    buffer_load_dwordx4 v3, s[12:15], s65 offen sc1 lds
    s_add_u32 s65, s65, 2048
    s_add_u32 m0, s78, s56
    s_nop 0
    buffer_load_dwordx4 v3, s[12:15], s66 offen sc1 lds
    s_add_u32 s66, s66, 2048
    s_add_u32 m0, s79, s56
    s_nop 0
    buffer_load_dwordx4 v3, s[12:15], s67 offen sc1 lds
    s_add_u32 s67, s67, 2048
    s_add_u32 s56, s56, 16384
    s_cmp_ge_u32 s56, 65536
    s_cselect_b32 s56, 0, s56
    s_sub_u32 s57, s57, 1
    s_cmp_lg_u32 s57, 0
    s_cbranch_scc1 LA3_F
    s_waitcnt vmcnt(16)
    s_barrier
    s_add_u32 m0, s72, s56
    s_nop 0
    buffer_load_dwordx4 v3, s[12:15], s60 offen sc1 lds
    s_add_u32 s60, s60, 2048
    s_add_u32 m0, s73, s56
    s_nop 0
    buffer_load_dwordx4 v3, s[12:15], s61 offen sc1 lds
    s_add_u32 s61, s61, 2048
    s_add_u32 m0, s74, s56
    s_nop 0
    buffer_load_dwordx4 v3, s[12:15], s62 offen sc1 lds
    s_add_u32 s62, s62, 2048
    s_add_u32 m0, s75, s56
    s_nop 0
    buffer_load_dwordx4 v3, s[12:15], s63 offen sc1 lds
    s_add_u32 s63, s63, 2048
    s_add_u32 m0, s76, s56
    s_nop 0
    buffer_load_dwordx4 v3, s[12:15], s64 offen sc1 lds
    s_add_u32 s64, s64, 2048
    s_add_u32 m0, s77, s56
    s_nop 0
    buffer_load_dwordx4 v3, s[12:15], s65 offen sc1 lds
    s_add_u32 s65, s65, 2048
    s_add_u32 m0, s78, s56
    s_nop 0
    buffer_load_dwordx4 v3, s[12:15], s66 offen sc1 lds
    s_add_u32 s66, s66, 2048
    s_add_u32 m0, s79, s56
    s_nop 0
    buffer_load_dwordx4 v3, s[12:15], s67 offen sc1 lds
    s_add_u32 s67, s67, 2048
    s_add_u32 s56, s56, 16384
    s_cmp_ge_u32 s56, 65536
    s_cselect_b32 s56, 0, s56
    s_mov_b32 s57, 2
LA3_L:
    s_waitcnt vmcnt(16)
    s_barrier
    s_add_u32 m0, s72, s56
    s_nop 0
    buffer_load_dwordx4 v3, s[12:15], s60 offen sc1 lds
    s_add_u32 s60, s60, 2048
    s_add_u32 m0, s73, s56
    s_nop 0
    buffer_load_dwordx4 v3, s[12:15], s61 offen sc1 lds
    s_add_u32 s61, s61, 2048
    s_add_u32 m0, s74, s56
    s_nop 0
    buffer_load_dwordx4 v3, s[12:15], s62 offen sc1 lds
    s_add_u32 s62, s62, 2048
    s_add_u32 m0, s75, s56
    s_nop 0
    buffer_load_dwordx4 v3, s[12:15], s63 offen sc1 lds
    s_add_u32 s63, s63, 2048
    s_add_u32 m0, s76, s56
    s_nop 0
    buffer_load_dwordx4 v3, s[12:15], s64 offen sc1 lds
    s_add_u32 s64, s64, 2048
    s_add_u32 m0, s77, s56
    s_nop 0
    buffer_load_dwordx4 v3, s[12:15], s65 offen sc1 lds
    s_add_u32 s65, s65, 2048
    s_add_u32 m0, s78, s56
    s_nop 0
    buffer_load_dwordx4 v3, s[12:15], s66 offen sc1 lds
    s_add_u32 s66, s66, 2048
    s_add_u32 m0, s79, s56
    s_nop 0
    buffer_load_dwordx4 v3, s[12:15], s67 offen sc1 lds
    s_add_u32 s67, s67, 2048
    s_add_u32 s56, s56, 16384
    s_cmp_ge_u32 s56, 65536
    s_cselect_b32 s56, 0, s56
    s_waitcnt vmcnt(16)
    s_barrier
    s_add_u32 m0, s72, s56
    s_nop 0
    buffer_load_dwordx4 v3, s[12:15], s60 offen sc1 lds
    s_add_u32 s60, s60, 2048
    s_add_u32 m0, s73, s56
    s_nop 0
    buffer_load_dwordx4 v3, s[12:15], s61 offen sc1 lds
    s_add_u32 s61, s61, 2048
    s_add_u32 m0, s74, s56
    s_nop 0
    buffer_load_dwordx4 v3, s[12:15], s62 offen sc1 lds
    s_add_u32 s62, s62, 2048
    s_add_u32 m0, s75, s56
    s_nop 0
    buffer_load_dwordx4 v3, s[12:15], s63 offen sc1 lds
    s_add_u32 s63, s63, 2048
    s_add_u32 m0, s76, s56
    s_nop 0
    buffer_load_dwordx4 v3, s[12:15], s64 offen sc1 lds
    s_add_u32 s64, s64, 2048
    s_add_u32 m0, s77, s56
    s_nop 0
    buffer_load_dwordx4 v3, s[12:15], s65 offen sc1 lds
    s_add_u32 s65, s65, 2048
    s_add_u32 m0, s78, s56
    s_nop 0
    buffer_load_dwordx4 v3, s[12:15], s66 offen sc1 lds
    s_add_u32 s66, s66, 2048
    s_add_u32 m0, s79, s56
    s_nop 0
    buffer_load_dwordx4 v3, s[12:15], s67 offen sc1 lds
    s_add_u32 s67, s67, 2048
    s_add_u32 s56, s56, 16384
    s_cmp_ge_u32 s56, 65536
    s_cselect_b32 s56, 0, s56
    s_waitcnt vmcnt(16)
    s_barrier
    s_add_u32 m0, s72, s56
    s_nop 0
    buffer_load_dwordx4 v3, s[12:15], s60 offen sc1 lds
    s_add_u32 s60, s60, 2048
    s_add_u32 m0, s73, s56
    s_nop 0
    buffer_load_dwordx4 v3, s[12:15], s61 offen sc1 lds
    s_add_u32 s61, s61, 2048
    s_add_u32 m0, s74, s56
    s_nop 0
    buffer_load_dwordx4 v3, s[12:15], s62 offen sc1 lds
    s_add_u32 s62, s62, 2048
    s_add_u32 m0, s75, s56
    s_nop 0
    buffer_load_dwordx4 v3, s[12:15], s63 offen sc1 lds
    s_add_u32 s63, s63, 2048
    s_add_u32 m0, s76, s56
    s_nop 0
    buffer_load_dwordx4 v3, s[12:15], s64 offen sc1 lds
    s_add_u32 s64, s64, 2048
    s_add_u32 m0, s77, s56
    s_nop 0
    buffer_load_dwordx4 v3, s[12:15], s65 offen sc1 lds
    s_add_u32 s65, s65, 2048
    s_add_u32 m0, s78, s56
    s_nop 0
    buffer_load_dwordx4 v3, s[12:15], s66 offen sc1 lds
    s_add_u32 s66, s66, 2048
    s_add_u32 m0, s79, s56
    s_nop 0
    buffer_load_dwordx4 v3, s[12:15], s67 offen sc1 lds
    s_add_u32 s67, s67, 2048
    s_add_u32 s56, s56, 16384
    s_cmp_ge_u32 s56, 65536
    s_cselect_b32 s56, 0, s56
    s_sub_u32 s57, s57, 1
    s_cmp_lg_u32 s57, 0
    s_cbranch_scc1 LA3_L
    s_waitcnt vmcnt(16)
    s_barrier
    s_waitcnt vmcnt(8)
    s_barrier
    s_waitcnt vmcnt(0)
    s_barrier
    s_barrier
    v_and_b32 v4, 31, v1
    v_lshlrev_b32 v4, 7, v4
    s_lshl_b32 s30, s20, 12
    s_add_u32 s30, s30, 524288
    s_mul_i32 s60, s26, 1024
    s_add_u32 s72, s60, 0
    s_add_u32 s60, s60, 0
    s_add_u32 s60, s60, s43
    s_mul_i32 s61, s26, 1024
    s_add_u32 s73, s61, 2048
    s_add_u32 s61, s61, 55296
    s_add_u32 s61, s61, s43
    s_mul_i32 s62, s26, 1024
    s_add_u32 s74, s62, 4096
    s_add_u32 s62, s62, 110592
    s_add_u32 s62, s62, s43
    s_mul_i32 s63, s26, 1024
    s_add_u32 s75, s63, 6144
    s_add_u32 s63, s63, 165888
    s_add_u32 s63, s63, s43
    s_mov_b32 s56, 0
    s_barrier
    s_mov_b32 s31, 0
M_POLL4:
    buffer_load_dword v5, v4, s[12:15], s30 offen sc1
    s_add_u32 s31, s31, 1
    s_waitcnt vmcnt(0)
    v_cmp_eq_u32 vcc, 0, v5
    s_cmp_gt_u32 s31, 200000
    s_cselect_b64 s[32:33], 0, vcc
    s_cmp_lg_u64 s[32:33], 0
    s_cbranch_scc1 M_POLL4
    s_mov_b32 s57, 4
LA4_F:
    s_add_u32 m0, s72, s56
    s_nop 0
    buffer_load_dwordx4 v3, s[12:15], s60 offen sc1 lds
    s_add_u32 s60, s60, 2048
    s_add_u32 m0, s73, s56
    s_nop 0
    buffer_load_dwordx4 v3, s[12:15], s61 offen sc1 lds
    s_add_u32 s61, s61, 2048
    s_add_u32 m0, s74, s56
    s_nop 0
    buffer_load_dwordx4 v3, s[12:15], s62 offen sc1 lds
    s_add_u32 s62, s62, 2048
    s_add_u32 m0, s75, s56
    s_nop 0
    buffer_load_dwordx4 v3, s[12:15], s63 offen sc1 lds
    s_add_u32 s63, s63, 2048
    s_add_u32 s56, s56, 8192
    s_cmp_ge_u32 s56, 49152
    s_cselect_b32 s56, 0, s56
    s_sub_u32 s57, s57, 1
    s_cmp_lg_u32 s57, 0
    s_cbranch_scc1 LA4_F
    s_waitcnt vmcnt(12)
    s_barrier
    s_add_u32 m0, s72, s56
    s_nop 0
    buffer_load_dwordx4 v3, s[12:15], s60 offen sc1 lds
    s_add_u32 s60, s60, 2048
    s_add_u32 m0, s73, s56
    s_nop 0
    buffer_load_dwordx4 v3, s[12:15], s61 offen sc1 lds
    s_add_u32 s61, s61, 2048
    s_add_u32 m0, s74, s56
    s_nop 0
    buffer_load_dwordx4 v3, s[12:15], s62 offen sc1 lds
    s_add_u32 s62, s62, 2048
    s_add_u32 m0, s75, s56
    s_nop 0
    buffer_load_dwordx4 v3, s[12:15], s63 offen sc1 lds
    s_add_u32 s63, s63, 2048
    s_add_u32 s56, s56, 8192
    s_cmp_ge_u32 s56, 49152
    s_cselect_b32 s56, 0, s56
    s_waitcnt vmcnt(12)
    s_barrier
    s_add_u32 m0, s72, s56
    s_nop 0
    buffer_load_dwordx4 v3, s[12:15], s60 offen sc1 lds
    s_add_u32 s60, s60, 2048
    s_add_u32 m0, s73, s56
    s_nop 0
    buffer_load_dwordx4 v3, s[12:15], s61 offen sc1 lds
    s_add_u32 s61, s61, 2048
    s_add_u32 m0, s74, s56
    s_nop 0
    buffer_load_dwordx4 v3, s[12:15], s62 offen sc1 lds
    s_add_u32 s62, s62, 2048
    s_add_u32 m0, s75, s56
    s_nop 0
    buffer_load_dwordx4 v3, s[12:15], s63 offen sc1 lds
    s_add_u32 s63, s63, 2048
    s_add_u32 s56, s56, 8192
    s_cmp_ge_u32 s56, 49152
    s_cselect_b32 s56, 0, s56
    s_mov_b32 s57, 7
LA4_L:
    s_waitcnt vmcnt(12)
    s_barrier
    s_add_u32 m0, s72, s56
    s_nop 0
    buffer_load_dwordx4 v3, s[12:15], s60 offen sc1 lds
    s_add_u32 s60, s60, 2048
    s_add_u32 m0, s73, s56
    s_nop 0
    buffer_load_dwordx4 v3, s[12:15], s61 offen sc1 lds
    s_add_u32 s61, s61, 2048
    s_add_u32 m0, s74, s56
    s_nop 0
    buffer_load_dwordx4 v3, s[12:15], s62 offen sc1 lds
    s_add_u32 s62, s62, 2048
    s_add_u32 m0, s75, s56
    s_nop 0
    buffer_load_dwordx4 v3, s[12:15], s63 offen sc1 lds
    s_add_u32 s63, s63, 2048
    s_add_u32 s56, s56, 8192
    s_cmp_ge_u32 s56, 49152
    s_cselect_b32 s56, 0, s56
    s_waitcnt vmcnt(12)
    s_barrier
    s_add_u32 m0, s72, s56
    s_nop 0
    buffer_load_dwordx4 v3, s[12:15], s60 offen sc1 lds
    s_add_u32 s60, s60, 2048
    s_add_u32 m0, s73, s56
    s_nop 0
    buffer_load_dwordx4 v3, s[12:15], s61 offen sc1 lds
    s_add_u32 s61, s61, 2048
    s_add_u32 m0, s74, s56
    s_nop 0
    buffer_load_dwordx4 v3, s[12:15], s62 offen sc1 lds
    s_add_u32 s62, s62, 2048
    s_add_u32 m0, s75, s56
    s_nop 0
    buffer_load_dwordx4 v3, s[12:15], s63 offen sc1 lds
    s_add_u32 s63, s63, 2048
    s_add_u32 s56, s56, 8192
    s_cmp_ge_u32 s56, 49152
    s_cselect_b32 s56, 0, s56
    s_waitcnt vmcnt(12)
    s_barrier
    s_add_u32 m0, s72, s56
    s_nop 0
    buffer_load_dwordx4 v3, s[12:15], s60 offen sc1 lds
    s_add_u32 s60, s60, 2048
    s_add_u32 m0, s73, s56
    s_nop 0
    buffer_load_dwordx4 v3, s[12:15], s61 offen sc1 lds
    s_add_u32 s61, s61, 2048
    s_add_u32 m0, s74, s56
    s_nop 0
    buffer_load_dwordx4 v3, s[12:15], s62 offen sc1 lds
    s_add_u32 s62, s62, 2048
    s_add_u32 m0, s75, s56
    s_nop 0
    buffer_load_dwordx4 v3, s[12:15], s63 offen sc1 lds
    s_add_u32 s63, s63, 2048
    s_add_u32 s56, s56, 8192
    s_cmp_ge_u32 s56, 49152
    s_cselect_b32 s56, 0, s56
    s_sub_u32 s57, s57, 1
    s_cmp_lg_u32 s57, 0
    s_cbranch_scc1 LA4_L
    s_waitcnt vmcnt(12)
    s_barrier
    s_waitcnt vmcnt(8)
    s_barrier
    s_waitcnt vmcnt(4)
    s_barrier
    s_waitcnt vmcnt(0)
    s_barrier
    s_barrier
    s_endpgm
M_BLOADER:
    s_mul_i32 s60, s26, 1024
    s_add_u32 s72, s60, 0
    s_add_u32 s60, s60, 8192
    s_add_u32 s60, s60, s46
    s_mul_i32 s61, s26, 1024
    s_add_u32 s73, s61, 2048
    s_add_u32 s61, s61, 28672
    s_add_u32 s61, s61, s46
    s_mul_i32 s62, s26, 1024
    s_add_u32 s74, s62, 4096
    s_add_u32 s62, s62, 49152
    s_add_u32 s62, s62, s46
    s_mul_i32 s63, s26, 1024
    s_add_u32 s75, s63, 6144
    s_add_u32 s63, s63, 69632
    s_add_u32 s63, s63, s46
    s_mul_i32 s64, s26, 1024
    s_add_u32 s76, s64, 8192
    s_add_u32 s64, s64, 90112
    s_add_u32 s64, s64, s46
    s_mov_b32 s56, 61440
    s_mov_b32 s57, 4
LBB_F:
    s_add_u32 m0, s72, s56
    s_nop 0
    buffer_load_dwordx4 v3, s[12:15], s60 offen  lds
    s_add_u32 s60, s60, 2048
    s_add_u32 m0, s73, s56
    s_nop 0
    buffer_load_dwordx4 v3, s[12:15], s61 offen  lds
    s_add_u32 s61, s61, 2048
    s_add_u32 m0, s74, s56
    s_nop 0
    buffer_load_dwordx4 v3, s[12:15], s62 offen  lds
    s_add_u32 s62, s62, 2048
    s_add_u32 m0, s75, s56
    s_nop 0
    buffer_load_dwordx4 v3, s[12:15], s63 offen  lds
    s_add_u32 s63, s63, 2048
    s_add_u32 m0, s76, s56
    s_nop 0
    buffer_load_dwordx4 v3, s[12:15], s64 offen  lds
    s_add_u32 s64, s64, 2048
    s_add_u32 s56, s56, 10240
    s_cmp_ge_u32 s56, 163840
    s_cselect_b32 s56, 61440, s56
    s_sub_u32 s57, s57, 1
    s_cmp_lg_u32 s57, 0
    s_cbranch_scc1 LBB_F
    s_waitcnt vmcnt(35)
    s_barrier
    s_add_u32 m0, s72, s56
    s_nop 0
    buffer_load_dwordx4 v3, s[12:15], s60 offen  lds
    s_add_u32 s60, s60, 2048
    s_add_u32 m0, s73, s56
    s_nop 0
    buffer_load_dwordx4 v3, s[12:15], s61 offen  lds
    s_add_u32 s61, s61, 2048
    s_add_u32 m0, s74, s56
    s_nop 0
    buffer_load_dwordx4 v3, s[12:15], s62 offen  lds
    s_add_u32 s62, s62, 2048
    s_add_u32 m0, s75, s56
    s_nop 0
    buffer_load_dwordx4 v3, s[12:15], s63 offen  lds
    s_add_u32 s63, s63, 2048
    s_add_u32 m0, s76, s56
    s_nop 0
    buffer_load_dwordx4 v3, s[12:15], s64 offen  lds
    s_add_u32 s64, s64, 2048
    s_add_u32 s56, s56, 10240
    s_cmp_ge_u32 s56, 163840
    s_cselect_b32 s56, 61440, s56
    s_waitcnt vmcnt(35)
    s_barrier
    s_add_u32 m0, s72, s56
    s_nop 0
    buffer_load_dwordx4 v3, s[12:15], s60 offen  lds
    s_add_u32 s60, s60, 2048
    s_add_u32 m0, s73, s56
    s_nop 0
    buffer_load_dwordx4 v3, s[12:15], s61 offen  lds
    s_add_u32 s61, s61, 2048
    s_add_u32 m0, s74, s56
    s_nop 0
    buffer_load_dwordx4 v3, s[12:15], s62 offen  lds
    s_add_u32 s62, s62, 2048
    s_add_u32 m0, s75, s56
    s_nop 0
    buffer_load_dwordx4 v3, s[12:15], s63 offen  lds
    s_add_u32 s63, s63, 2048
    s_add_u32 m0, s76, s56
    s_nop 0
    buffer_load_dwordx4 v3, s[12:15], s64 offen  lds
    s_add_u32 s64, s64, 2048
    s_add_u32 s56, s56, 10240
    s_cmp_ge_u32 s56, 163840
    s_cselect_b32 s56, 61440, s56
    s_waitcnt vmcnt(35)
    s_barrier
    s_waitcnt vmcnt(30)
    s_barrier
    s_waitcnt vmcnt(25)
    s_barrier
    s_waitcnt vmcnt(20)
    s_barrier
    s_waitcnt vmcnt(15)
    s_barrier
    s_waitcnt vmcnt(10)
    s_barrier
    s_waitcnt vmcnt(5)
    s_barrier
    s_waitcnt vmcnt(0)
    s_barrier
    s_barrier
    s_mul_i32 s60, s26, 1024
    s_add_u32 s72, s60, 0
    s_add_u32 s60, s60, 0
    s_add_u32 s60, s60, s27
    s_mul_i32 s61, s26, 1024
    s_add_u32 s73, s61, 2048
    s_add_u32 s61, s61, 20480
    s_add_u32 s61, s61, s27
    s_mul_i32 s62, s26, 1024
    s_add_u32 s74, s62, 4096
    s_add_u32 s62, s62, 40960
    s_add_u32 s62, s62, s27
    s_mul_i32 s63, s26, 1024
    s_add_u32 s75, s63, 6144
    s_add_u32 s63, s63, 61440
    s_add_u32 s63, s63, s27
    s_mul_i32 s64, s26, 1024
    s_add_u32 s76, s64, 8192
    s_add_u32 s64, s64, 81920
    s_add_u32 s64, s64, s27
    s_mul_i32 s65, s26, 1024
    s_add_u32 s77, s65, 10240
    s_add_u32 s65, s65, 102400
    s_add_u32 s65, s65, s27
    s_mul_i32 s66, s26, 1024
    s_add_u32 s78, s66, 12288
    s_add_u32 s66, s66, 122880
    s_add_u32 s66, s66, s27
    s_mov_b32 s56, 65536
    s_mov_b32 s57, 3
LB3_E:
    s_add_u32 m0, s72, s56
    s_nop 0
    buffer_load_dwordx4 v3, s[12:15], s60 offen  lds
    s_add_u32 s60, s60, 2048
    s_add_u32 m0, s73, s56
    s_nop 0
    buffer_load_dwordx4 v3, s[12:15], s61 offen  lds
    s_add_u32 s61, s61, 2048
    s_add_u32 m0, s74, s56
    s_nop 0
    buffer_load_dwordx4 v3, s[12:15], s62 offen  lds
    s_add_u32 s62, s62, 2048
    s_add_u32 m0, s75, s56
    s_nop 0
    buffer_load_dwordx4 v3, s[12:15], s63 offen  lds
    s_add_u32 s63, s63, 2048
    s_add_u32 m0, s76, s56
    s_nop 0
    buffer_load_dwordx4 v3, s[12:15], s64 offen  lds
    s_add_u32 s64, s64, 2048
    s_add_u32 m0, s77, s56
    s_nop 0
    buffer_load_dwordx4 v3, s[12:15], s65 offen  lds
    s_add_u32 s65, s65, 2048
    s_add_u32 m0, s78, s56
    s_nop 0
    buffer_load_dwordx4 v3, s[12:15], s66 offen  lds
    s_add_u32 s66, s66, 2048
    s_add_u32 s56, s56, 14336
    s_cmp_ge_u32 s56, 151552
    s_cselect_b32 s56, 65536, s56
    s_sub_u32 s57, s57, 1
    s_cmp_lg_u32 s57, 0
    s_cbranch_scc1 LB3_E
    s_barrier
    s_mov_b32 s57, 2
LB3_F:
    s_add_u32 m0, s72, s56
    s_nop 0
    buffer_load_dwordx4 v3, s[12:15], s60 offen  lds
    s_add_u32 s60, s60, 2048
    s_add_u32 m0, s73, s56
    s_nop 0
    buffer_load_dwordx4 v3, s[12:15], s61 offen  lds
    s_add_u32 s61, s61, 2048
    s_add_u32 m0, s74, s56
    s_nop 0
    buffer_load_dwordx4 v3, s[12:15], s62 offen  lds
    s_add_u32 s62, s62, 2048
    s_add_u32 m0, s75, s56
    s_nop 0
    buffer_load_dwordx4 v3, s[12:15], s63 offen  lds
    s_add_u32 s63, s63, 2048
    s_add_u32 m0, s76, s56
    s_nop 0
    buffer_load_dwordx4 v3, s[12:15], s64 offen  lds
    s_add_u32 s64, s64, 2048
    s_add_u32 m0, s77, s56
    s_nop 0
    buffer_load_dwordx4 v3, s[12:15], s65 offen  lds
    s_add_u32 s65, s65, 2048
    s_add_u32 m0, s78, s56
    s_nop 0
    buffer_load_dwordx4 v3, s[12:15], s66 offen  lds
    s_add_u32 s66, s66, 2048
    s_add_u32 s56, s56, 14336
    s_cmp_ge_u32 s56, 151552
    s_cselect_b32 s56, 65536, s56
    s_sub_u32 s57, s57, 1
    s_cmp_lg_u32 s57, 0
    s_cbranch_scc1 LB3_F
    s_waitcnt vmcnt(28)
    s_barrier
    s_add_u32 m0, s72, s56
    s_nop 0
    buffer_load_dwordx4 v3, s[12:15], s60 offen  lds
    s_add_u32 s60, s60, 2048
    s_add_u32 m0, s73, s56
    s_nop 0
    buffer_load_dwordx4 v3, s[12:15], s61 offen  lds
    s_add_u32 s61, s61, 2048
    s_add_u32 m0, s74, s56
    s_nop 0
    buffer_load_dwordx4 v3, s[12:15], s62 offen  lds
    s_add_u32 s62, s62, 2048
    s_add_u32 m0, s75, s56
    s_nop 0
    buffer_load_dwordx4 v3, s[12:15], s63 offen  lds
    s_add_u32 s63, s63, 2048
    s_add_u32 m0, s76, s56
    s_nop 0
    buffer_load_dwordx4 v3, s[12:15], s64 offen  lds
    s_add_u32 s64, s64, 2048
    s_add_u32 m0, s77, s56
    s_nop 0
    buffer_load_dwordx4 v3, s[12:15], s65 offen  lds
    s_add_u32 s65, s65, 2048
    s_add_u32 m0, s78, s56
    s_nop 0
    buffer_load_dwordx4 v3, s[12:15], s66 offen  lds
    s_add_u32 s66, s66, 2048
    s_add_u32 s56, s56, 14336
    s_cmp_ge_u32 s56, 151552
    s_cselect_b32 s56, 65536, s56
    s_waitcnt vmcnt(28)
    s_barrier
    s_add_u32 m0, s72, s56
    s_nop 0
    buffer_load_dwordx4 v3, s[12:15], s60 offen  lds
    s_add_u32 s60, s60, 2048
    s_add_u32 m0, s73, s56
    s_nop 0
    buffer_load_dwordx4 v3, s[12:15], s61 offen  lds
    s_add_u32 s61, s61, 2048
    s_add_u32 m0, s74, s56
    s_nop 0
    buffer_load_dwordx4 v3, s[12:15], s62 offen  lds
    s_add_u32 s62, s62, 2048
    s_add_u32 m0, s75, s56
    s_nop 0
    buffer_load_dwordx4 v3, s[12:15], s63 offen  lds
    s_add_u32 s63, s63, 2048
    s_add_u32 m0, s76, s56
    s_nop 0
    buffer_load_dwordx4 v3, s[12:15], s64 offen  lds
    s_add_u32 s64, s64, 2048
    s_add_u32 m0, s77, s56
    s_nop 0
    buffer_load_dwordx4 v3, s[12:15], s65 offen  lds
    s_add_u32 s65, s65, 2048
    s_add_u32 m0, s78, s56
    s_nop 0
    buffer_load_dwordx4 v3, s[12:15], s66 offen  lds
    s_add_u32 s66, s66, 2048
    s_add_u32 s56, s56, 14336
    s_cmp_ge_u32 s56, 151552
    s_cselect_b32 s56, 65536, s56
    s_waitcnt vmcnt(28)
    s_barrier
    s_add_u32 m0, s72, s56
    s_nop 0
    buffer_load_dwordx4 v3, s[12:15], s60 offen  lds
    s_add_u32 s60, s60, 2048
    s_add_u32 m0, s73, s56
    s_nop 0
    buffer_load_dwordx4 v3, s[12:15], s61 offen  lds
    s_add_u32 s61, s61, 2048
    s_add_u32 m0, s74, s56
    s_nop 0
    buffer_load_dwordx4 v3, s[12:15], s62 offen  lds
    s_add_u32 s62, s62, 2048
    s_add_u32 m0, s75, s56
    s_nop 0
    buffer_load_dwordx4 v3, s[12:15], s63 offen  lds
    s_add_u32 s63, s63, 2048
    s_add_u32 m0, s76, s56
    s_nop 0
    buffer_load_dwordx4 v3, s[12:15], s64 offen  lds
    s_add_u32 s64, s64, 2048
    s_add_u32 m0, s77, s56
    s_nop 0
    buffer_load_dwordx4 v3, s[12:15], s65 offen  lds
    s_add_u32 s65, s65, 2048
    s_add_u32 m0, s78, s56
    s_nop 0
    buffer_load_dwordx4 v3, s[12:15], s66 offen  lds
    s_add_u32 s66, s66, 2048
    s_add_u32 s56, s56, 14336
    s_cmp_ge_u32 s56, 151552
    s_cselect_b32 s56, 65536, s56
    s_waitcnt vmcnt(28)
    s_barrier
    s_add_u32 m0, s72, s56
    s_nop 0
    buffer_load_dwordx4 v3, s[12:15], s60 offen  lds
    s_add_u32 s60, s60, 2048
    s_add_u32 m0, s73, s56
    s_nop 0
    buffer_load_dwordx4 v3, s[12:15], s61 offen  lds
    s_add_u32 s61, s61, 2048
    s_add_u32 m0, s74, s56
    s_nop 0
    buffer_load_dwordx4 v3, s[12:15], s62 offen  lds
    s_add_u32 s62, s62, 2048
    s_add_u32 m0, s75, s56
    s_nop 0
    buffer_load_dwordx4 v3, s[12:15], s63 offen  lds
    s_add_u32 s63, s63, 2048
    s_add_u32 m0, s76, s56
    s_nop 0
    buffer_load_dwordx4 v3, s[12:15], s64 offen  lds
    s_add_u32 s64, s64, 2048
    s_add_u32 m0, s77, s56
    s_nop 0
    buffer_load_dwordx4 v3, s[12:15], s65 offen  lds
    s_add_u32 s65, s65, 2048
    s_add_u32 m0, s78, s56
    s_nop 0
    buffer_load_dwordx4 v3, s[12:15], s66 offen  lds
    s_add_u32 s66, s66, 2048
    s_add_u32 s56, s56, 14336
    s_cmp_ge_u32 s56, 151552
    s_cselect_b32 s56, 65536, s56
    s_waitcnt vmcnt(28)
    s_barrier
    s_add_u32 m0, s72, s56
    s_nop 0
    buffer_load_dwordx4 v3, s[12:15], s60 offen  lds
    s_add_u32 s60, s60, 2048
    s_add_u32 m0, s73, s56
    s_nop 0
    buffer_load_dwordx4 v3, s[12:15], s61 offen  lds
    s_add_u32 s61, s61, 2048
    s_add_u32 m0, s74, s56
    s_nop 0
    buffer_load_dwordx4 v3, s[12:15], s62 offen  lds
    s_add_u32 s62, s62, 2048
    s_add_u32 m0, s75, s56
    s_nop 0
    buffer_load_dwordx4 v3, s[12:15], s63 offen  lds
    s_add_u32 s63, s63, 2048
    s_add_u32 m0, s76, s56
    s_nop 0
    buffer_load_dwordx4 v3, s[12:15], s64 offen  lds
    s_add_u32 s64, s64, 2048
    s_add_u32 m0, s77, s56
    s_nop 0
    buffer_load_dwordx4 v3, s[12:15], s65 offen  lds
    s_add_u32 s65, s65, 2048
    s_add_u32 m0, s78, s56
    s_nop 0
    buffer_load_dwordx4 v3, s[12:15], s66 offen  lds
    s_add_u32 s66, s66, 2048
    s_add_u32 s56, s56, 14336
    s_cmp_ge_u32 s56, 151552
    s_cselect_b32 s56, 65536, s56
    s_waitcnt vmcnt(28)
    s_barrier
    s_waitcnt vmcnt(21)
    s_barrier
    s_waitcnt vmcnt(14)
    s_barrier
    s_waitcnt vmcnt(7)
    s_barrier
    s_waitcnt vmcnt(0)
    s_barrier
    s_barrier
    s_mul_i32 s60, s26, 1024
    s_add_u32 s72, s60, 0
    s_add_u32 s60, s60, 0
    s_add_u32 s60, s60, s44
    s_mul_i32 s61, s26, 1024
    s_add_u32 s73, s61, 2048
    s_add_u32 s61, s61, 55296
    s_add_u32 s61, s61, s44
    s_mul_i32 s62, s26, 1024
    s_add_u32 s74, s62, 4096
    s_add_u32 s62, s62, 110592
    s_add_u32 s62, s62, s44
    s_mul_i32 s63, s26, 1024
    s_add_u32 s75, s63, 6144
    s_add_u32 s63, s63, 165888
    s_add_u32 s63, s63, s44
    s_mul_i32 s64, s26, 1024
    s_add_u32 s76, s64, 8192
    s_add_u32 s64, s64, 221184
    s_add_u32 s64, s64, s44
    s_mov_b32 s56, 49152
    s_mov_b32 s57, 11
LB4_E:
    s_add_u32 m0, s72, s56
    s_nop 0
    buffer_load_dwordx4 v3, s[12:15], s60 offen  lds
    s_add_u32 s60, s60, 2048
    s_add_u32 m0, s73, s56
    s_nop 0
    buffer_load_dwordx4 v3, s[12:15], s61 offen  lds
    s_add_u32 s61, s61, 2048
    s_add_u32 m0, s74, s56
    s_nop 0
    buffer_load_dwordx4 v3, s[12:15], s62 offen  lds
    s_add_u32 s62, s62, 2048
    s_add_u32 m0, s75, s56
    s_nop 0
    buffer_load_dwordx4 v3, s[12:15], s63 offen  lds
    s_add_u32 s63, s63, 2048
    s_add_u32 m0, s76, s56
    s_nop 0
    buffer_load_dwordx4 v3, s[12:15], s64 offen  lds
    s_add_u32 s64, s64, 2048
    s_add_u32 s56, s56, 10240
    s_cmp_ge_u32 s56, 161792
    s_cselect_b32 s56, 49152, s56
    s_sub_u32 s57, s57, 1
    s_cmp_lg_u32 s57, 0
    s_cbranch_scc1 LB4_E
    s_barrier
    s_waitcnt vmcnt(50)
    s_barrier
    s_waitcnt vmcnt(45)
    s_barrier
    s_add_u32 m0, s72, s56
    s_nop 0
    buffer_load_dwordx4 v3, s[12:15], s60 offen  lds
    s_add_u32 s60, s60, 2048
    s_add_u32 m0, s73, s56
    s_nop 0
    buffer_load_dwordx4 v3, s[12:15], s61 offen  lds
    s_add_u32 s61, s61, 2048
    s_add_u32 m0, s74, s56
    s_nop 0
    buffer_load_dwordx4 v3, s[12:15], s62 offen  lds
    s_add_u32 s62, s62, 2048
    s_add_u32 m0, s75, s56
    s_nop 0
    buffer_load_dwordx4 v3, s[12:15], s63 offen  lds
    s_add_u32 s63, s63, 2048
    s_add_u32 m0, s76, s56
    s_nop 0
    buffer_load_dwordx4 v3, s[12:15], s64 offen  lds
    s_add_u32 s64, s64, 2048
    s_add_u32 s56, s56, 10240
    s_cmp_ge_u32 s56, 161792
    s_cselect_b32 s56, 49152, s56
    s_mov_b32 s57, 5
LB4_L:
    s_waitcnt vmcnt(45)
    s_barrier
    s_add_u32 m0, s72, s56
    s_nop 0
    buffer_load_dwordx4 v3, s[12:15], s60 offen  lds
    s_add_u32 s60, s60, 2048
    s_add_u32 m0, s73, s56
    s_nop 0
    buffer_load_dwordx4 v3, s[12:15], s61 offen  lds
    s_add_u32 s61, s61, 2048
    s_add_u32 m0, s74, s56
    s_nop 0
    buffer_load_dwordx4 v3, s[12:15], s62 offen  lds
    s_add_u32 s62, s62, 2048
    s_add_u32 m0, s75, s56
    s_nop 0
    buffer_load_dwordx4 v3, s[12:15], s63 offen  lds
    s_add_u32 s63, s63, 2048
    s_add_u32 m0, s76, s56
    s_nop 0
    buffer_load_dwordx4 v3, s[12:15], s64 offen  lds
    s_add_u32 s64, s64, 2048
    s_add_u32 s56, s56, 10240
    s_cmp_ge_u32 s56, 161792
    s_cselect_b32 s56, 49152, s56
    s_waitcnt vmcnt(45)
    s_barrier
    s_add_u32 m0, s72, s56
    s_nop 0
    buffer_load_dwordx4 v3, s[12:15], s60 offen  lds
    s_add_u32 s60, s60, 2048
    s_add_u32 m0, s73, s56
    s_nop 0
    buffer_load_dwordx4 v3, s[12:15], s61 offen  lds
    s_add_u32 s61, s61, 2048
    s_add_u32 m0, s74, s56
    s_nop 0
    buffer_load_dwordx4 v3, s[12:15], s62 offen  lds
    s_add_u32 s62, s62, 2048
    s_add_u32 m0, s75, s56
    s_nop 0
    buffer_load_dwordx4 v3, s[12:15], s63 offen  lds
    s_add_u32 s63, s63, 2048
    s_add_u32 m0, s76, s56
    s_nop 0
    buffer_load_dwordx4 v3, s[12:15], s64 offen  lds
    s_add_u32 s64, s64, 2048
    s_add_u32 s56, s56, 10240
    s_cmp_ge_u32 s56, 161792
    s_cselect_b32 s56, 49152, s56
    s_waitcnt vmcnt(45)
    s_barrier
    s_add_u32 m0, s72, s56
    s_nop 0
    buffer_load_dwordx4 v3, s[12:15], s60 offen  lds
    s_add_u32 s60, s60, 2048
    s_add_u32 m0, s73, s56
    s_nop 0
    buffer_load_dwordx4 v3, s[12:15], s61 offen  lds
    s_add_u32 s61, s61, 2048
    s_add_u32 m0, s74, s56
    s_nop 0
    buffer_load_dwordx4 v3, s[12:15], s62 offen  lds
    s_add_u32 s62, s62, 2048
    s_add_u32 m0, s75, s56
    s_nop 0
    buffer_load_dwordx4 v3, s[12:15], s63 offen  lds
    s_add_u32 s63, s63, 2048
    s_add_u32 m0, s76, s56
    s_nop 0
    buffer_load_dwordx4 v3, s[12:15], s64 offen  lds
    s_add_u32 s64, s64, 2048
    s_add_u32 s56, s56, 10240
    s_cmp_ge_u32 s56, 161792
    s_cselect_b32 s56, 49152, s56
    s_sub_u32 s57, s57, 1
    s_cmp_lg_u32 s57, 0
    s_cbranch_scc1 LB4_L
    s_waitcnt vmcnt(45)
    s_barrier
    s_waitcnt vmcnt(40)
    s_barrier
    s_waitcnt vmcnt(35)
    s_barrier
    s_waitcnt vmcnt(30)
    s_barrier
    s_waitcnt vmcnt(25)
    s_barrier
    s_waitcnt vmcnt(20)
    s_barrier
    s_waitcnt vmcnt(15)
    s_barrier
    s_waitcnt vmcnt(10)
    s_barrier
    s_waitcnt vmcnt(5)
    s_barrier
    s_waitcnt vmcnt(0)
    s_barrier
    s_barrier
    s_endpgm
CODE_END:
    s_endpgm
.section .rodata,"a"
.p2align 6
.p2align 6
.amdhsa_kernel prep_kernel
  .amdhsa_next_free_vgpr 96
  .amdhsa_next_free_sgpr 102
  .amdhsa_accum_offset 96
  .amdhsa_group_segment_fixed_size 0
  .amdhsa_kernarg_size 120
  .amdhsa_user_sgpr_count 2
  .amdhsa_user_sgpr_kernarg_segment_ptr 1
  .amdhsa_system_sgpr_workgroup_id_x 1
  .amdhsa_float_denorm_mode_32 3
  .amdhsa_float_denorm_mode_16_64 3
.end_amdhsa_kernel
.p2align 6
.amdhsa_kernel main_kernel
  .amdhsa_next_free_vgpr 256
  .amdhsa_next_free_sgpr 102
  .amdhsa_accum_offset 256
  .amdhsa_group_segment_fixed_size 0
  .amdhsa_kernarg_size 120
  .amdhsa_user_sgpr_count 2
  .amdhsa_user_sgpr_kernarg_segment_ptr 1
  .amdhsa_system_sgpr_workgroup_id_x 1
  .amdhsa_float_denorm_mode_32 3
  .amdhsa_float_denorm_mode_16_64 3
.end_amdhsa_kernel
```
